```python
import torch

def _softmax(x, axis=-1):
    return torch.softmax(x, dim=axis)
def _gelu(x):
    return torch.nn.functional.gelu(x, approximate="tanh")
def _silu(x):
    return torch.nn.functional.silu(x)
def _sigmoid(x):
    return torch.sigmoid(x)
def _layernorm(x, axis=-1, eps=1e-5):
    m = x.mean(dim=axis, keepdim=True)
    v = x.var(dim=axis, keepdim=True, unbiased=False)
    return (x - m) / torch.sqrt(v + eps)
def _scatter_add(tgt, idx, src, axis=0):
    return tgt.clone().index_add_(axis, idx, src)
def _segment_sum(src, seg, n):
    out = torch.zeros((n,) + src.shape[1:], dtype=src.dtype)
    return out.index_add_(0, seg, src)
def _pad(x, pw):
    flat = tuple(v for pair in reversed(pw) for v in pair)
    return torch.nn.functional.pad(x, flat)

kernel_name = 'sequential_preLN__sliding_block__dense_activation_squared_relu__prompt'

def setup_inputs():

    _w = (lambda a: (lambda t: t.to(torch.bfloat16) if t.is_floating_point() else t)(torch.as_tensor(a)))
    def _A_setup():
        B, S, D = 1, 2048, 512
        return {
            "x": _w((lambda *s: torch.randn(*s, dtype=torch.bfloat16) * 0.05)(B, S, D)),
            "wqkv": _w((lambda *s: torch.randn(*s, dtype=torch.bfloat16) * 0.05)(D, 3 * D)),
            "wo": _w((lambda *s: torch.randn(*s, dtype=torch.bfloat16) * 0.05)(D, D)),
        }
    _A_in = _A_setup()

    def _B_setup():
        B, S, D, F = 1, 2048, 512, 1376
        return {
            "x": _w((lambda *s: torch.randn(*s, dtype=torch.bfloat16) * 0.05)(B, S, D)),
            "w1": _w((lambda *s: torch.randn(*s, dtype=torch.bfloat16) * 0.05)(D, F)),
            "b1": _w((lambda *s: torch.randn(*s, dtype=torch.bfloat16) * 0.4)(F)),
            "w2": _w((lambda *s: torch.randn(*s, dtype=torch.bfloat16) * 0.05)(F, D)),
            "b2": _w((lambda *s: torch.randn(*s, dtype=torch.bfloat16) * 1.6)(D)),
        }
    _B_in = _B_setup()

    return {
        "A_x": _A_in["x"],
        "A_wqkv": _A_in["wqkv"],
        "A_wo": _A_in["wo"],
        "B_x": _B_in["x"],
        "B_w1": _B_in["w1"],
        "B_b1": _B_in["b1"],
        "B_w2": _B_in["w2"],
        "B_b2": _B_in["b2"],
    }

def reference(A_x, A_wqkv, A_wo, B_x, B_w1, B_b1, B_w2, B_b2):
    def _A_ref(x, wqkv, wo):
        B, S, D = x.shape
        H = 32; Dh = D // H; W = 256
        qkv = (lambda x, *d: x.permute(*d))((x @ wqkv).reshape(B, S, 3, H, Dh), 2, 0, 3, 1, 4)
        q, k, v = qkv[0], qkv[1], qkv[2]
        scores = torch.einsum("bhqd,bhkd->bhqk", q, k) * (Dh ** -0.5)
        idx = torch.arange(S)
        mask = (idx[:, None] - idx[None, :] >= 0) & (idx[:, None] - idx[None, :] < W)
        scores = torch.where(mask[None, None], scores, -1e9)
        p = _softmax(scores, axis=-1)
        o = torch.einsum("bhqk,bhkd->bhqd", p, v)
        return (lambda x, *d: x.permute(*d))(o, 0, 2, 1, 3).reshape(B, S, D) @ wo

    def _B_ref(x, w1, b1, w2, b2):
        h = torch.einsum("bsd,df->bsf", x, w1) + b1
        zero = torch.zeros_like(h)
        r = torch.where(h > zero, h, zero)
        h = r * r
        out = torch.einsum("bsf,fd->bsd", h, w2) + b2
        return out

    x = A_x
    h = x + _A_ref(_layernorm(x, axis=-1), A_wqkv, A_wo)
    h2 = h + _B_ref(_layernorm(h, axis=-1), B_w1, B_b1, B_w2, B_b2)
    return h2
```

```asm
; @launch grid=(256,1,1) block=(512,1,1) lds=163840
.amdgcn_target "amdgcn-amd-amdhsa--gfx950"
.text
.globl sequential_preLN__sliding_block__dense_activation_squared_relu__prompt_kernel
.p2align 8
.type sequential_preLN__sliding_block__dense_activation_squared_relu__prompt_kernel,@function
sequential_preLN__sliding_block__dense_activation_squared_relu__prompt_kernel:
    s_cmp_ge_u32 s2, 256
    s_cbranch_scc1 L_end
    s_load_dwordx16 s[64:79], s[0:1], 0
    s_load_dwordx4 s[80:83], s[0:1], 64
    s_load_dwordx2 s[84:85], s[0:1], 80
    s_getpc_b64 s[56:57]
L_pc:
    s_sub_u32 s56, s56, L_pc-sequential_preLN__sliding_block__dense_activation_squared_relu__prompt_kernel
    s_subb_u32 s57, s57, 0
    s_lshr_b32 s55, s2, 3
    s_lshl_b32 s55, s55, 11
    v_lshrrev_b32 v10, 5, v0
    v_lshlrev_b32 v10, 7, v10
    v_add_u32 v10, s55, v10
    v_min_u32 v10, L_codeend-sequential_preLN__sliding_block__dense_activation_squared_relu__prompt_kernel-4, v10
    global_load_dword v253, v10, s[56:57]
    v_and_b32 v1, 63, v0
    v_lshrrev_b32 v2, 6, v0
    s_nop 0
    v_readfirstlane_b32 s50, v2
    s_and_b32 s44, s2, 7
    s_lshr_b32 s45, s2, 3
    s_and_b32 s47, s45, 15
    s_lshr_b32 s55, s45, 4
    s_lshl_b32 s46, s44, 1
    s_add_u32 s46, s46, s55
    v_lshlrev_b32 v2, 4, v1
    s_and_b32 s63, s50, 3
    v_lshrrev_b32 v3, 3, v1
    s_lshl_b32 s55, s63, 5
    v_add_u32 v3, s55, v3
    v_and_b32 v10, 7, v1
    s_lshl_b32 s56, s46, 17
    v_bfe_u32 v11, v3, 1, 3
    v_xor_b32 v11, v10, v11
    v_lshlrev_b32 v11, 4, v11
    v_lshl_add_u32 v4, v3, 10, v11
    v_add_u32 v4, s56, v4
    v_xor_b32 v5, 64, v4
    v_add_u32 v5, 8192, v5
    v_lshrrev_b32 v10, 3, v1
    s_lshl_b32 s55, s63, 4
    v_add_u32 v10, s55, v10
    s_movk_i32 s59, 3072
    v_mul_lo_u32 v10, v10, s59
    v_bfe_u32 v11, v1, 2, 1
    v_bfe_u32 v12, v1, 4, 1
    v_xor_b32 v11, v11, v12
    v_lshl_add_u32 v10, v11, 10, v10
    v_and_b32 v11, 3, v1
    v_lshl_add_u32 v10, v11, 4, v10
    s_lshl_b32 s56, s47, 6
    s_add_u32 s56, s56, 1024
    v_add_u32 v6, s56, v10
    s_lshl_b32 s96, s63, 12
    s_lshl_b32 s97, s63, 11
    s_lshl_b32 s3, s45, 2
    s_add_u32 s3, s3, s63
    s_lshr_b32 s55, s3, 1
    s_mul_i32 s55, s55, 3072
    s_and_b32 s3, s3, 1
    s_lshl_b32 s3, s3, 10
    s_add_u32 s3, s3, s55
    s_add_u32 s3, s3, 1024
    v_bfe_u32 v16, v1, 3, 1
    v_mul_u32_u24 v16, 196608, v16
    v_and_b32 v15, 7, v1
    v_lshl_add_u32 v16, v15, 7, v16
    v_min_u32 v17, 11, v1
    v_lshlrev_b32 v17, 7, v17
    s_lshl_b32 s60, s46, 4
    s_add_u32 s60, s60, s47
    s_lshl_b32 s60, s60, 3
    s_add_u32 s60, s60, s63
    s_waitcnt lgkmcnt(0)
    s_mov_b32 s4, s64
    s_and_b32 s5, s65, 0xffff
    s_mov_b32 s6, 2097152
    s_mov_b32 s7, 0x20000
    s_cmp_ge_u32 s50, 4
    s_cbranch_scc1 L_norow
    s_load_dword s52, s[84:85], 0
    s_lshl_b32 s55, s45, 2
    s_add_u32 s55, s55, s50
    s_and_b32 s55, s55, 15
    s_mov_b64 s[90:91], s[84:85]
    s_cmp_eq_u32 s55, 0
    s_cselect_b64 s[90:91], s[68:69], s[90:91]
    s_cmp_eq_u32 s55, 1
    s_cselect_b64 s[90:91], s[72:73], s[90:91]
    s_cmp_eq_u32 s55, 2
    s_cselect_b64 s[90:91], s[74:75], s[90:91]
    s_cmp_eq_u32 s55, 3
    s_cselect_b64 s[90:91], s[76:77], s[90:91]
    s_cmp_eq_u32 s55, 4
    s_cselect_b64 s[90:91], s[78:79], s[90:91]
    s_cmp_eq_u32 s55, 5
    s_cselect_b64 s[90:91], s[80:81], s[90:91]
    s_sub_i32 s55, s55, 6
    s_max_i32 s55, s55, 0
    s_lshl_b32 s55, s55, 20
    s_add_u32 s90, s90, s55
    s_addc_u32 s91, s91, 0
    s_load_dword s92, s[90:91], 0
    s_lshl_b32 s55, s60, 10
    s_add_u32 s56, s55, 4096
    buffer_load_dwordx4 v[196:199], v2, s[4:7], s55 offen
    buffer_load_dwordx4 v[208:211], v2, s[4:7], s56 offen
L_norow:
    s_mov_b32 s8, s66
    s_and_b32 s9, s67, 0xffff
    s_mov_b32 s10, 1572864
    s_mov_b32 s11, 0x20000
    s_cmp_lt_u32 s50, 4
    s_cbranch_scc1 L_CW
    s_add_u32 s62, s3, 0
    buffer_load_dword v252, v16, s[8:11], s62 offen
    s_mov_b32 s62, 0
    s_add_u32 m0, s97, 19456
    s_nop 0
    buffer_load_dwordx4 v6, s[8:11], s62 offen lds
    s_mov_b32 s62, 0
    s_add_u32 m0, s96, 3072
    s_nop 0
    buffer_load_dwordx4 v4, s[4:7], s62 offen lds
    s_mov_b32 s62, 0
    s_add_u32 m0, s96, 4096
    s_nop 0
    buffer_load_dwordx4 v5, s[4:7], s62 offen lds
    s_mov_b32 s62, 24576
    s_add_u32 m0, s97, 20480
    s_nop 0
    buffer_load_dwordx4 v6, s[8:11], s62 offen lds
    s_mov_b32 s62, 16384
    s_add_u32 m0, s96, 5120
    s_nop 0
    buffer_load_dwordx4 v4, s[4:7], s62 offen lds
    s_mov_b32 s62, 16384
    s_add_u32 m0, s96, 6144
    s_nop 0
    buffer_load_dwordx4 v5, s[4:7], s62 offen lds
    s_add_u32 s62, s3, 393216
    buffer_load_dword v252, v16, s[8:11], s62 offen
    s_add_u32 s62, s3, 786432
    buffer_load_dword v252, v16, s[8:11], s62 offen
    s_add_u32 s62, s3, 1179648
    buffer_load_dword v252, v16, s[8:11], s62 offen
    s_mov_b32 s12, s68
    s_and_b32 s13, s69, 0xffff
    s_mov_b32 s14, 524288
    s_mov_b32 s15, 0x20000
    s_mov_b32 s16, s72
    s_and_b32 s17, s73, 0xffff
    s_mov_b32 s18, 1409024
    s_mov_b32 s19, 0x20000
    s_mov_b32 s20, s76
    s_and_b32 s21, s77, 0xffff
    s_mov_b32 s22, 1409024
    s_mov_b32 s23, 0x20000
    v_bfe_u32 v10, v1, 2, 2
    v_lshrrev_b32 v11, 5, v1
    v_lshl_add_u32 v10, v11, 3, v10
    v_lshlrev_b32 v10, 7, v10
    v_bfe_u32 v11, v1, 4, 1
    v_lshl_add_u32 v10, v11, 5, v10
    v_and_b32 v11, 3, v1
    v_lshl_add_u32 v10, v11, 3, v10
    v_bfe_u32 v11, v1, 3, 1
    v_lshl_add_u32 v19, v11, 6, v10
    s_and_b32 s55, s63, 1
    s_lshl_b32 s55, s55, 6
    v_xor_b32 v19, s55, v19
    s_sub_u32 s51, 7, s50
    v_and_b32 v10, 31, v1
    s_lshl_b32 s55, s51, 5
    v_add_u32 v10, s55, v10
    v_bfe_u32 v11, v10, 1, 3
    v_lshrrev_b32 v12, 5, v1
    v_xor_b32 v11, v11, v12
    v_lshlrev_b32 v11, 4, v11
    v_lshl_add_u32 v9, v10, 7, v11
    v_mov_b32 v104, 0x3f803f80
    v_mov_b32 v105, 0x3f803f80
    v_mov_b32 v106, 0x3f803f80
    v_mov_b32 v107, 0x3f803f80
    v_mov_b32 v10, 0
    v_mov_b32 v11, 0
    v_lshlrev_b32 v12, 3, v1
    v_and_b32 v12, 63, v12
    ds_write_b64 v12, v[10:11] offset:2816
    s_mov_b32 s28, s84
    s_and_b32 s29, s85, 0xffff
    s_mov_b32 s30, 11534336
    s_mov_b32 s31, 0x20000
    s_mov_b32 s32, s74
    s_and_b32 s33, s75, 0xffff
    s_mov_b32 s34, 2752
    s_mov_b32 s35, 0x20000
    s_mov_b32 s36, s78
    s_and_b32 s37, s79, 0xffff
    s_mov_b32 s38, 1024
    s_mov_b32 s39, 0x20000
    s_mov_b32 s24, s80
    s_and_b32 s25, s81, 0xffff
    s_mov_b32 s26, 2097152
    s_mov_b32 s27, 0x20000
    s_lshr_b32 s55, s45, 3
    s_lshl_b32 s48, s44, 2
    s_add_u32 s48, s48, s55
    s_and_b32 s49, s45, 7
    s_lshr_b32 s54, s50, 2
    s_lshl_b32 s88, s46, 4
    s_add_u32 s88, s88, s47
    s_lshl_b32 s88, s88, 14
    s_add_u32 s88, s88, 1048576
    s_sub_u32 s51, 7, s50
    v_mov_b32 v18, 0x3f803f80
    s_movk_i32 s58, 5462
    s_movk_i32 s59, 2752
    s_mul_i32 s56, s47, 192
    v_add_u32 v10, 0, v1
    v_mul_lo_u32 v11, v10, s58
    v_lshrrev_b32 v11, 16, v11
    v_mul_u32_u24 v12, 12, v11
    v_sub_u32 v12, v10, v12
    v_lshlrev_b32 v12, 4, v12
    v_mul_lo_u32 v11, v11, s59
    v_add3_u32 v112, v11, v12, s56
    v_add_u32 v10, 64, v1
    v_mul_lo_u32 v11, v10, s58
    v_lshrrev_b32 v11, 16, v11
    v_mul_u32_u24 v12, 12, v11
    v_sub_u32 v12, v10, v12
    v_lshlrev_b32 v12, 4, v12
    v_mul_lo_u32 v11, v11, s59
    v_add3_u32 v113, v11, v12, s56
    v_add_u32 v10, 128, v1
    v_mul_lo_u32 v11, v10, s58
    v_lshrrev_b32 v11, 16, v11
    v_mul_u32_u24 v12, 12, v11
    v_sub_u32 v12, v10, v12
    v_lshlrev_b32 v12, 4, v12
    v_mul_lo_u32 v11, v11, s59
    v_add3_u32 v114, v11, v12, s56
    v_and_b32 v10, 31, v1
    v_lshrrev_b32 v11, 5, v1
    v_lshlrev_b32 v11, 2, v11
    v_sub_u32 v10, v10, v11
    v_mov_b32 v12, 0xf149f2ca
    v_mov_b32 v13, 0
    v_cmp_le_i32 s[56:57], 0, v10
    v_cmp_le_i32 s[58:59], 1, v10
    v_cmp_le_i32 s[60:61], 2, v10
    v_cmp_le_i32 s[62:63], 3, v10
    v_cndmask_b32 v164, v12, v13, s[56:57]
    v_cndmask_b32 v180, v13, v12, s[56:57]
    v_cndmask_b32 v165, v12, v13, s[58:59]
    v_cndmask_b32 v181, v13, v12, s[58:59]
    v_cndmask_b32 v166, v12, v13, s[60:61]
    v_cndmask_b32 v182, v13, v12, s[60:61]
    v_cndmask_b32 v167, v12, v13, s[62:63]
    v_cndmask_b32 v183, v13, v12, s[62:63]
    v_cmp_le_i32 s[56:57], 8, v10
    v_cmp_le_i32 s[58:59], 9, v10
    v_cmp_le_i32 s[60:61], 10, v10
    v_cmp_le_i32 s[62:63], 11, v10
    v_cndmask_b32 v168, v12, v13, s[56:57]
    v_cndmask_b32 v184, v13, v12, s[56:57]
    v_cndmask_b32 v169, v12, v13, s[58:59]
    v_cndmask_b32 v185, v13, v12, s[58:59]
    v_cndmask_b32 v170, v12, v13, s[60:61]
    v_cndmask_b32 v186, v13, v12, s[60:61]
    v_cndmask_b32 v171, v12, v13, s[62:63]
    v_cndmask_b32 v187, v13, v12, s[62:63]
    v_cmp_le_i32 s[56:57], 16, v10
    v_cmp_le_i32 s[58:59], 17, v10
    v_cmp_le_i32 s[60:61], 18, v10
    v_cmp_le_i32 s[62:63], 19, v10
    v_cndmask_b32 v172, v12, v13, s[56:57]
    v_cndmask_b32 v188, v13, v12, s[56:57]
    v_cndmask_b32 v173, v12, v13, s[58:59]
    v_cndmask_b32 v189, v13, v12, s[58:59]
    v_cndmask_b32 v174, v12, v13, s[60:61]
    v_cndmask_b32 v190, v13, v12, s[60:61]
    v_cndmask_b32 v175, v12, v13, s[62:63]
    v_cndmask_b32 v191, v13, v12, s[62:63]
    v_cmp_le_i32 s[56:57], 24, v10
    v_cmp_le_i32 s[58:59], 25, v10
    v_cmp_le_i32 s[60:61], 26, v10
    v_cmp_le_i32 s[62:63], 27, v10
    v_cndmask_b32 v176, v12, v13, s[56:57]
    v_cndmask_b32 v192, v13, v12, s[56:57]
    v_cndmask_b32 v177, v12, v13, s[58:59]
    v_cndmask_b32 v193, v13, v12, s[58:59]
    v_cndmask_b32 v178, v12, v13, s[60:61]
    v_cndmask_b32 v194, v13, v12, s[60:61]
    v_cndmask_b32 v179, v12, v13, s[62:63]
    v_cndmask_b32 v195, v13, v12, s[62:63]
    s_and_b32 s63, s50, 3
    v_lshrrev_b32 v10, 3, v1
    v_lshlrev_b32 v10, 10, v10
    v_and_b32 v11, 7, v1
    v_bfe_u32 v12, v1, 4, 1
    v_lshlrev_b32 v12, 2, v12
    v_xor_b32 v11, v11, v12
    v_lshl_add_u32 v10, v11, 4, v10
    s_lshl_b32 s55, s49, 7
    v_add_u32 v115, s55, v10
    s_lshl_b32 s55, s51, 11
    s_lshl_b32 s56, s54, 10
    s_add_u32 s55, s55, s56
    s_add_u32 s55, s55, 68608
    v_add_u32 v100, s55, v2
    v_and_b32 v10, 47, v1
    s_lshl_b32 s56, s54, 4
    v_add_u32 v10, s56, v10
    v_lshlrev_b32 v10, 4, v10
    v_and_b32 v11, 16, v1
    v_cmp_ne_u32 vcc, 0, v11
    v_mov_b32 v11, 1024
    s_nop 0
    v_cndmask_b32 v10, v10, v11, vcc
    s_mul_i32 s55, s51, 2080
    s_add_u32 s55, s55, 93184
    v_add_u32 v101, s55, v10
    v_lshrrev_b32 v10, 2, v1
    s_lshl_b32 s55, s63, 7
    v_add_u32 v10, s55, v10
    s_movk_i32 s56, 3072
    v_mul_lo_u32 v10, v10, s56
    v_and_b32 v11, 3, v1
    v_lshl_add_u32 v10, v11, 4, v10
    s_lshl_b32 s56, s47, 6
    v_add_u32 v7, s56, v10
    v_bfe_u32 v10, v1, 2, 2
    v_lshrrev_b32 v11, 5, v1
    v_lshl_add_u32 v10, v11, 3, v10
    v_lshlrev_b32 v10, 6, v10
    v_bfe_u32 v11, v1, 4, 1
    v_lshl_add_u32 v10, v11, 5, v10
    v_and_b32 v11, 3, v1
    v_lshl_add_u32 v10, v11, 3, v10
    v_add_u32 v8, 118784, v10
    s_mov_b32 s62, 196608
    s_add_u32 m0, s97, 44032
    s_nop 0
    buffer_load_dwordx4 v6, s[8:11], s62 offen lds
    s_mov_b32 s62, 128
    s_add_u32 m0, s96, 27648
    s_nop 0
    buffer_load_dwordx4 v4, s[4:7], s62 offen lds
    s_mov_b32 s62, 128
    s_add_u32 m0, s96, 28672
    s_nop 0
    buffer_load_dwordx4 v5, s[4:7], s62 offen lds
    s_mov_b32 s62, 221184
    s_add_u32 m0, s97, 45056
    s_nop 0
    buffer_load_dwordx4 v6, s[8:11], s62 offen lds
    s_mov_b32 s62, 16512
    s_add_u32 m0, s96, 29696
    s_nop 0
    buffer_load_dwordx4 v4, s[4:7], s62 offen lds
    s_mov_b32 s62, 16512
    s_add_u32 m0, s96, 30720
    s_nop 0
    buffer_load_dwordx4 v5, s[4:7], s62 offen lds
    v_add_u32 v14, 19456, v19
    v_add_u32 v108, 3072, v9
    v_xor_b32 v109, 32, v108
    v_xor_b32 v116, 64, v108
    v_xor_b32 v117, 96, v108
    s_waitcnt vmcnt(9)
    s_waitcnt lgkmcnt(0)
    s_barrier
    ds_read_b64_tr_b16 v[36:37], v14 offset:0
    ds_read_b64_tr_b16 v[38:39], v14 offset:512
    ds_read_b64_tr_b16 v[40:41], v14 offset:2048
    ds_read_b64_tr_b16 v[42:43], v14 offset:2560
    ds_read_b64_tr_b16 v[44:45], v14 offset:4096
    ds_read_b64_tr_b16 v[46:47], v14 offset:4608
    ds_read_b64_tr_b16 v[48:49], v14 offset:6144
    ds_read_b64_tr_b16 v[50:51], v14 offset:6656
    ds_read_b128 v[20:23], v108
    ds_read_b128 v[24:27], v109
    ds_read_b128 v[28:31], v116
    ds_read_b128 v[32:35], v117
    s_mov_b32 s62, 393216
    s_add_u32 m0, s97, 68608
    s_nop 0
    buffer_load_dwordx4 v6, s[8:11], s62 offen lds
    s_mov_b32 s62, 256
    s_add_u32 m0, s96, 52224
    s_nop 0
    buffer_load_dwordx4 v4, s[4:7], s62 offen lds
    s_waitcnt lgkmcnt(0)
    v_mfma_f32_32x32x16_bf16 v[52:67], v[104:107], v[36:39], 0
    s_mov_b32 s62, 256
    s_add_u32 m0, s96, 53248
    s_nop 0
    buffer_load_dwordx4 v5, s[4:7], s62 offen lds
    v_mfma_f32_32x32x16_bf16 v[52:67], v[104:107], v[40:43], v[52:67]
    s_mov_b32 s62, 417792
    s_add_u32 m0, s97, 69632
    s_nop 0
    buffer_load_dwordx4 v6, s[8:11], s62 offen lds
    v_mfma_f32_32x32x16_bf16 v[52:67], v[104:107], v[44:47], v[52:67]
    s_mov_b32 s62, 16640
    s_add_u32 m0, s96, 54272
    s_nop 0
    buffer_load_dwordx4 v4, s[4:7], s62 offen lds
    v_mfma_f32_32x32x16_bf16 v[52:67], v[104:107], v[48:51], v[52:67]
    s_mov_b32 s62, 16640
    s_add_u32 m0, s96, 55296
    s_nop 0
    buffer_load_dwordx4 v5, s[4:7], s62 offen lds
    s_lshl_b32 s62, s45, 2
    s_add_u32 s62, s62, s63
    s_mul_i32 s62, s62, 12288
    v_bfe_u32 v3, v1, 3, 2
    v_mul_u32_u24 v3, 3072, v3
    v_and_b32 v110, 7, v1
    v_lshl_add_u32 v3, v110, 7, v3
    buffer_load_dword v252, v3, s[8:11], s62 offen
    v_add_u32 v14, 44032, v19
    v_add_u32 v108, 27648, v9
    v_xor_b32 v109, 32, v108
    v_xor_b32 v116, 64, v108
    v_xor_b32 v117, 96, v108
    s_waitcnt vmcnt(7)
    s_barrier
    ds_read_b64_tr_b16 v[36:37], v14 offset:0
    ds_read_b64_tr_b16 v[38:39], v14 offset:512
    ds_read_b64_tr_b16 v[40:41], v14 offset:2048
    ds_read_b64_tr_b16 v[42:43], v14 offset:2560
    ds_read_b64_tr_b16 v[44:45], v14 offset:4096
    ds_read_b64_tr_b16 v[46:47], v14 offset:4608
    ds_read_b64_tr_b16 v[48:49], v14 offset:6144
    ds_read_b64_tr_b16 v[50:51], v14 offset:6656
    ds_read_b128 v[68:71], v108
    ds_read_b128 v[72:75], v109
    ds_read_b128 v[76:79], v116
    ds_read_b128 v[80:83], v117
    s_mov_b32 s62, 589824
    s_add_u32 m0, s97, 93184
    s_nop 0
    buffer_load_dwordx4 v6, s[8:11], s62 offen lds
    s_mov_b32 s62, 384
    s_add_u32 m0, s96, 76800
    s_nop 0
    buffer_load_dwordx4 v4, s[4:7], s62 offen lds
    s_waitcnt lgkmcnt(0)
    v_mfma_f32_32x32x16_bf16 v[52:67], v[104:107], v[36:39], v[52:67]
    s_mov_b32 s62, 384
    s_add_u32 m0, s96, 77824
    s_nop 0
    buffer_load_dwordx4 v5, s[4:7], s62 offen lds
    v_mfma_f32_32x32x16_bf16 v[52:67], v[104:107], v[40:43], v[52:67]
    s_mov_b32 s62, 614400
    s_add_u32 m0, s97, 94208
    s_nop 0
    buffer_load_dwordx4 v6, s[8:11], s62 offen lds
    v_mfma_f32_32x32x16_bf16 v[52:67], v[104:107], v[44:47], v[52:67]
    s_mov_b32 s62, 16768
    s_add_u32 m0, s96, 78848
    s_nop 0
    buffer_load_dwordx4 v4, s[4:7], s62 offen lds
    v_mfma_f32_32x32x16_bf16 v[52:67], v[104:107], v[48:51], v[52:67]
    s_mov_b32 s62, 16768
    s_add_u32 m0, s96, 79872
    s_nop 0
    buffer_load_dwordx4 v5, s[4:7], s62 offen lds
    v_mov_b32 v10, 2560
    ds_read_b32 v10, v10
    s_waitcnt lgkmcnt(0)
    v_readfirstlane_b32 s52, v10
    v_add_u32 v14, 68608, v19
    v_add_u32 v108, 52224, v9
    v_xor_b32 v109, 32, v108
    v_xor_b32 v116, 64, v108
    v_xor_b32 v117, 96, v108
    s_waitcnt vmcnt(7)
    s_barrier
    ds_read_b64_tr_b16 v[36:37], v14 offset:0
    ds_read_b64_tr_b16 v[38:39], v14 offset:512
    ds_read_b64_tr_b16 v[40:41], v14 offset:2048
    ds_read_b64_tr_b16 v[42:43], v14 offset:2560
    ds_read_b64_tr_b16 v[44:45], v14 offset:4096
    ds_read_b64_tr_b16 v[46:47], v14 offset:4608
    ds_read_b64_tr_b16 v[48:49], v14 offset:6144
    ds_read_b64_tr_b16 v[50:51], v14 offset:6656
    ds_read_b128 v[84:87], v108
    ds_read_b128 v[88:91], v109
    ds_read_b128 v[92:95], v116
    ds_read_b128 v[96:99], v117
    s_mov_b32 s62, 786432
    s_add_u32 m0, s97, 19456
    s_nop 0
    buffer_load_dwordx4 v6, s[8:11], s62 offen lds
    s_mov_b32 s62, 512
    s_add_u32 m0, s96, 3072
    s_nop 0
    buffer_load_dwordx4 v4, s[4:7], s62 offen lds
    s_waitcnt lgkmcnt(0)
    v_mfma_f32_32x32x16_bf16 v[52:67], v[104:107], v[36:39], v[52:67]
    s_mov_b32 s62, 512
    s_add_u32 m0, s96, 4096
    s_nop 0
    buffer_load_dwordx4 v5, s[4:7], s62 offen lds
    v_mfma_f32_32x32x16_bf16 v[52:67], v[104:107], v[40:43], v[52:67]
    s_mov_b32 s62, 811008
    s_add_u32 m0, s97, 20480
    s_nop 0
    buffer_load_dwordx4 v6, s[8:11], s62 offen lds
    v_mfma_f32_32x32x16_bf16 v[52:67], v[104:107], v[44:47], v[52:67]
    s_mov_b32 s62, 16896
    s_add_u32 m0, s96, 5120
    s_nop 0
    buffer_load_dwordx4 v4, s[4:7], s62 offen lds
    v_mfma_f32_32x32x16_bf16 v[52:67], v[104:107], v[48:51], v[52:67]
    s_mov_b32 s62, 16896
    s_add_u32 m0, s96, 6144
    s_nop 0
    buffer_load_dwordx4 v5, s[4:7], s62 offen lds
    v_add_u32 v14, 93184, v19
    v_add_u32 v108, 76800, v9
    v_xor_b32 v109, 32, v108
    v_xor_b32 v116, 64, v108
    v_xor_b32 v117, 96, v108
    s_waitcnt vmcnt(6)
    s_barrier
    ds_read_b64_tr_b16 v[36:37], v14 offset:0
    ds_read_b64_tr_b16 v[38:39], v14 offset:512
    ds_read_b64_tr_b16 v[40:41], v14 offset:2048
    ds_read_b64_tr_b16 v[42:43], v14 offset:2560
    ds_read_b64_tr_b16 v[44:45], v14 offset:4096
    ds_read_b64_tr_b16 v[46:47], v14 offset:4608
    ds_read_b64_tr_b16 v[48:49], v14 offset:6144
    ds_read_b64_tr_b16 v[50:51], v14 offset:6656
    ds_read_b128 v[120:123], v108
    ds_read_b128 v[124:127], v109
    ds_read_b128 v[128:131], v116
    ds_read_b128 v[132:135], v117
    s_mov_b32 s62, 983040
    s_add_u32 m0, s97, 44032
    s_nop 0
    buffer_load_dwordx4 v6, s[8:11], s62 offen lds
    s_mov_b32 s62, 640
    s_add_u32 m0, s96, 27648
    s_nop 0
    buffer_load_dwordx4 v4, s[4:7], s62 offen lds
    s_waitcnt lgkmcnt(0)
    v_mfma_f32_32x32x16_bf16 v[52:67], v[104:107], v[36:39], v[52:67]
    s_mov_b32 s62, 640
    s_add_u32 m0, s96, 28672
    s_nop 0
    buffer_load_dwordx4 v5, s[4:7], s62 offen lds
    v_mfma_f32_32x32x16_bf16 v[52:67], v[104:107], v[40:43], v[52:67]
    s_mov_b32 s62, 1007616
    s_add_u32 m0, s97, 45056
    s_nop 0
    buffer_load_dwordx4 v6, s[8:11], s62 offen lds
    v_mfma_f32_32x32x16_bf16 v[52:67], v[104:107], v[44:47], v[52:67]
    s_mov_b32 s62, 17024
    s_add_u32 m0, s96, 29696
    s_nop 0
    buffer_load_dwordx4 v4, s[4:7], s62 offen lds
    v_mfma_f32_32x32x16_bf16 v[52:67], v[104:107], v[48:51], v[52:67]
    s_mov_b32 s62, 17024
    s_add_u32 m0, s96, 30720
    s_nop 0
    buffer_load_dwordx4 v5, s[4:7], s62 offen lds
    v_add_u32 v14, 19456, v19
    v_add_u32 v108, 3072, v9
    v_xor_b32 v109, 32, v108
    v_xor_b32 v116, 64, v108
    v_xor_b32 v117, 96, v108
    s_waitcnt vmcnt(6)
    s_barrier
    ds_read_b64_tr_b16 v[36:37], v14 offset:0
    ds_read_b64_tr_b16 v[38:39], v14 offset:512
    ds_read_b64_tr_b16 v[40:41], v14 offset:2048
    ds_read_b64_tr_b16 v[42:43], v14 offset:2560
    ds_read_b64_tr_b16 v[44:45], v14 offset:4096
    ds_read_b64_tr_b16 v[46:47], v14 offset:4608
    ds_read_b64_tr_b16 v[48:49], v14 offset:6144
    ds_read_b64_tr_b16 v[50:51], v14 offset:6656
    ds_read_b128 v[136:139], v108
    ds_read_b128 v[140:143], v109
    ds_read_b128 v[144:147], v116
    ds_read_b128 v[148:151], v117
    s_mov_b32 s62, 1179648
    s_add_u32 m0, s97, 68608
    s_nop 0
    buffer_load_dwordx4 v6, s[8:11], s62 offen lds
    s_mov_b32 s62, 768
    s_add_u32 m0, s96, 52224
    s_nop 0
    buffer_load_dwordx4 v4, s[4:7], s62 offen lds
    s_waitcnt lgkmcnt(0)
    v_mfma_f32_32x32x16_bf16 v[52:67], v[104:107], v[36:39], v[52:67]
    s_mov_b32 s62, 768
    s_add_u32 m0, s96, 53248
    s_nop 0
    buffer_load_dwordx4 v5, s[4:7], s62 offen lds
    v_mfma_f32_32x32x16_bf16 v[52:67], v[104:107], v[40:43], v[52:67]
    s_mov_b32 s62, 1204224
    s_add_u32 m0, s97, 69632
    s_nop 0
    buffer_load_dwordx4 v6, s[8:11], s62 offen lds
    v_mfma_f32_32x32x16_bf16 v[52:67], v[104:107], v[44:47], v[52:67]
    s_mov_b32 s62, 17152
    s_add_u32 m0, s96, 54272
    s_nop 0
    buffer_load_dwordx4 v4, s[4:7], s62 offen lds
    v_mfma_f32_32x32x16_bf16 v[52:67], v[104:107], v[48:51], v[52:67]
    s_mov_b32 s62, 17152
    s_add_u32 m0, s96, 55296
    s_nop 0
    buffer_load_dwordx4 v5, s[4:7], s62 offen lds
    v_add_u32 v14, 44032, v19
    v_add_u32 v108, 27648, v9
    v_xor_b32 v109, 32, v108
    v_xor_b32 v116, 64, v108
    v_xor_b32 v117, 96, v108
    s_waitcnt vmcnt(6)
    s_barrier
    ds_read_b64_tr_b16 v[36:37], v14 offset:0
    ds_read_b64_tr_b16 v[38:39], v14 offset:512
    ds_read_b64_tr_b16 v[40:41], v14 offset:2048
    ds_read_b64_tr_b16 v[42:43], v14 offset:2560
    ds_read_b64_tr_b16 v[44:45], v14 offset:4096
    ds_read_b64_tr_b16 v[46:47], v14 offset:4608
    ds_read_b64_tr_b16 v[48:49], v14 offset:6144
    ds_read_b64_tr_b16 v[50:51], v14 offset:6656
    ds_read_b128 v[152:155], v108
    ds_read_b128 v[156:159], v109
    ds_read_b128 v[196:199], v116
    ds_read_b128 v[200:203], v117
    s_mov_b32 s62, 1376256
    s_add_u32 m0, s97, 93184
    s_nop 0
    buffer_load_dwordx4 v6, s[8:11], s62 offen lds
    s_mov_b32 s62, 896
    s_add_u32 m0, s96, 76800
    s_nop 0
    buffer_load_dwordx4 v4, s[4:7], s62 offen lds
    s_waitcnt lgkmcnt(0)
    v_mfma_f32_32x32x16_bf16 v[52:67], v[104:107], v[36:39], v[52:67]
    s_mov_b32 s62, 896
    s_add_u32 m0, s96, 77824
    s_nop 0
    buffer_load_dwordx4 v5, s[4:7], s62 offen lds
    v_mfma_f32_32x32x16_bf16 v[52:67], v[104:107], v[40:43], v[52:67]
    s_mov_b32 s62, 1400832
    s_add_u32 m0, s97, 94208
    s_nop 0
    buffer_load_dwordx4 v6, s[8:11], s62 offen lds
    v_mfma_f32_32x32x16_bf16 v[52:67], v[104:107], v[44:47], v[52:67]
    s_mov_b32 s62, 17280
    s_add_u32 m0, s96, 78848
    s_nop 0
    buffer_load_dwordx4 v4, s[4:7], s62 offen lds
    v_mfma_f32_32x32x16_bf16 v[52:67], v[104:107], v[48:51], v[52:67]
    s_mov_b32 s62, 17280
    s_add_u32 m0, s96, 79872
    s_nop 0
    buffer_load_dwordx4 v5, s[4:7], s62 offen lds
    v_add_u32 v14, 68608, v19
    v_add_u32 v108, 52224, v9
    v_xor_b32 v109, 32, v108
    v_xor_b32 v116, 64, v108
    v_xor_b32 v117, 96, v108
    s_waitcnt vmcnt(6)
    s_barrier
    ds_read_b64_tr_b16 v[36:37], v14 offset:0
    ds_read_b64_tr_b16 v[38:39], v14 offset:512
    ds_read_b64_tr_b16 v[40:41], v14 offset:2048
    ds_read_b64_tr_b16 v[42:43], v14 offset:2560
    ds_read_b64_tr_b16 v[44:45], v14 offset:4096
    ds_read_b64_tr_b16 v[46:47], v14 offset:4608
    ds_read_b64_tr_b16 v[48:49], v14 offset:6144
    ds_read_b64_tr_b16 v[50:51], v14 offset:6656
    ds_read_b128 v[204:207], v108
    ds_read_b128 v[208:211], v109
    ds_read_b128 v[212:215], v116
    ds_read_b128 v[216:219], v117
    s_lshl_b32 s62, s63, 13
    s_add_u32 m0, s62, 118784
    s_mov_b32 s62, 0
    buffer_load_dwordx4 v7, s[8:11], s62 offen lds
    s_lshl_b32 s62, s63, 13
    s_add_u32 m0, s62, 119808
    s_mov_b32 s62, 49152
    buffer_load_dwordx4 v7, s[8:11], s62 offen lds
    s_waitcnt lgkmcnt(0)
    v_mfma_f32_32x32x16_bf16 v[52:67], v[104:107], v[36:39], v[52:67]
    s_lshl_b32 s62, s63, 13
    s_add_u32 m0, s62, 120832
    s_mov_b32 s62, 98304
    buffer_load_dwordx4 v7, s[8:11], s62 offen lds
    v_mfma_f32_32x32x16_bf16 v[52:67], v[104:107], v[40:43], v[52:67]
    s_lshl_b32 s62, s63, 13
    s_add_u32 m0, s62, 121856
    s_mov_b32 s62, 147456
    buffer_load_dwordx4 v7, s[8:11], s62 offen lds
    v_mfma_f32_32x32x16_bf16 v[52:67], v[104:107], v[44:47], v[52:67]
    s_lshl_b32 s62, s63, 13
    s_add_u32 m0, s62, 122880
    s_mov_b32 s62, 196608
    buffer_load_dwordx4 v7, s[8:11], s62 offen lds
    v_mfma_f32_32x32x16_bf16 v[52:67], v[104:107], v[48:51], v[52:67]
    s_lshl_b32 s62, s63, 13
    s_add_u32 m0, s62, 123904
    s_mov_b32 s62, 245760
    buffer_load_dwordx4 v7, s[8:11], s62 offen lds
    s_lshl_b32 s62, s63, 13
    s_add_u32 m0, s62, 124928
    s_mov_b32 s62, 294912
    buffer_load_dwordx4 v7, s[8:11], s62 offen lds
    s_lshl_b32 s62, s63, 13
    s_add_u32 m0, s62, 125952
    s_mov_b32 s62, 344064
    buffer_load_dwordx4 v7, s[8:11], s62 offen lds
    v_add_u32 v14, 93184, v19
    v_add_u32 v108, 76800, v9
    v_xor_b32 v109, 32, v108
    v_xor_b32 v116, 64, v108
    v_xor_b32 v117, 96, v108
    s_waitcnt vmcnt(8)
    s_barrier
    ds_read_b64_tr_b16 v[36:37], v14 offset:0
    ds_read_b64_tr_b16 v[38:39], v14 offset:512
    ds_read_b64_tr_b16 v[40:41], v14 offset:2048
    ds_read_b64_tr_b16 v[42:43], v14 offset:2560
    ds_read_b64_tr_b16 v[44:45], v14 offset:4096
    ds_read_b64_tr_b16 v[46:47], v14 offset:4608
    ds_read_b64_tr_b16 v[48:49], v14 offset:6144
    ds_read_b64_tr_b16 v[50:51], v14 offset:6656
    ds_read_b128 v[220:223], v108
    ds_read_b128 v[224:227], v109
    ds_read_b128 v[228:231], v116
    ds_read_b128 v[232:235], v117
    s_waitcnt lgkmcnt(0)
    v_mfma_f32_32x32x16_bf16 v[52:67], v[104:107], v[36:39], v[52:67]
    v_mfma_f32_32x32x16_bf16 v[52:67], v[104:107], v[40:43], v[52:67]
    v_mfma_f32_32x32x16_bf16 v[52:67], v[104:107], v[44:47], v[52:67]
    v_mfma_f32_32x32x16_bf16 v[52:67], v[104:107], v[48:51], v[52:67]
    v_and_b32 v10, 31, v1
    v_lshlrev_b32 v10, 2, v10
    s_and_b32 s55, s63, 1
    s_lshl_b32 s55, s55, 7
    v_add_u32 v11, s55, v10
    s_nop 6
    ds_write_b32 v11, v52 offset:1152
    s_waitcnt lgkmcnt(0)
    s_barrier
    v_min_u32 v15, 23, v1
    v_lshrrev_b32 v16, 3, v15
    v_add_u32 v16, s46, v16
    v_cmp_le_u32 vcc, 2, v16
    v_mov_b32 v13, 0
    s_nop 0
    v_cndmask_b32 v44, v13, v18, vcc
    v_mov_b32 v45, v44
    v_mov_b32 v46, v44
    v_mov_b32 v47, v44
    v_mul_u32_u24 v15, 1040, v15
    v_add_u32 v15, 94208, v15
    ds_write_b128 v15, v[44:47]
    v_mov_b32 v118, 0
    v_mov_b32 v119, 1
    s_lshl_b32 s55, s51, 7
    v_add_u32 v11, s55, v10
    ds_read_b32 v108, v11 offset:0
    ds_read_b32 v109, v11 offset:512
    s_waitcnt vmcnt(0)
    s_lshl_b32 s55, s63, 13
    v_add_u32 v14, s55, v8
    s_mov_b64 exec, 1
    ds_add_u32 v118, v119 offset:2844
    s_mov_b64 exec, -1
    ds_read_b64_tr_b16 v[36:37], v14 offset:0
    ds_read_b64_tr_b16 v[38:39], v14 offset:256
    ds_read_b64_tr_b16 v[40:41], v14 offset:1024
    ds_read_b64_tr_b16 v[42:43], v14 offset:1280
    ds_read_b64_tr_b16 v[44:45], v14 offset:2048
    ds_read_b64_tr_b16 v[46:47], v14 offset:2304
    ds_read_b64_tr_b16 v[48:49], v14 offset:3072
    ds_read_b64_tr_b16 v[50:51], v14 offset:3328
    s_waitcnt lgkmcnt(6)
    v_mfma_f32_32x32x16_bf16 v[52:67], v[104:107], v[36:39], 0
    ds_read_b64_tr_b16 v[36:37], v14 offset:4096
    ds_read_b64_tr_b16 v[38:39], v14 offset:4352
    s_waitcnt lgkmcnt(6)
    v_mfma_f32_32x32x16_bf16 v[52:67], v[104:107], v[40:43], v[52:67]
    ds_read_b64_tr_b16 v[40:41], v14 offset:5120
    ds_read_b64_tr_b16 v[42:43], v14 offset:5376
    s_waitcnt lgkmcnt(6)
    v_mfma_f32_32x32x16_bf16 v[52:67], v[104:107], v[44:47], v[52:67]
    ds_read_b64_tr_b16 v[44:45], v14 offset:6144
    ds_read_b64_tr_b16 v[46:47], v14 offset:6400
    s_waitcnt lgkmcnt(6)
    v_mfma_f32_32x32x16_bf16 v[52:67], v[104:107], v[48:51], v[52:67]
    ds_read_b64_tr_b16 v[48:49], v14 offset:7168
    ds_read_b64_tr_b16 v[50:51], v14 offset:7424
    s_waitcnt lgkmcnt(6)
    v_mfma_f32_32x32x16_bf16 v[52:67], v[104:107], v[36:39], v[52:67]
    s_waitcnt lgkmcnt(4)
    v_mfma_f32_32x32x16_bf16 v[52:67], v[104:107], v[40:43], v[52:67]
    s_waitcnt lgkmcnt(2)
    v_mfma_f32_32x32x16_bf16 v[52:67], v[104:107], v[44:47], v[52:67]
    s_waitcnt lgkmcnt(0)
    v_mfma_f32_32x32x16_bf16 v[52:67], v[104:107], v[48:51], v[52:67]
    ds_read_b32 v12, v118 offset:2844
    s_waitcnt lgkmcnt(0)
    v_cmp_gt_u32 vcc, 4, v12
    s_cbranch_vccnz L_lwx_2
L_lw_1:
    s_lshl_b32 s55, s63, 7
    v_add_u32 v11, s55, v10
    v_lshrrev_b32 v12, 5, v1
    v_lshlrev_b32 v12, 4, v12
    ds_read_b64_tr_b16 v[36:37], v8 offset:0
    ds_read_b64_tr_b16 v[38:39], v8 offset:256
    ds_read_b64_tr_b16 v[40:41], v8 offset:1024
    ds_read_b64_tr_b16 v[42:43], v8 offset:1280
    ds_read_b64_tr_b16 v[44:45], v8 offset:2048
    ds_read_b64_tr_b16 v[46:47], v8 offset:2304
    ds_read_b64_tr_b16 v[48:49], v8 offset:3072
    ds_read_b64_tr_b16 v[50:51], v8 offset:3328
    s_waitcnt lgkmcnt(6)
    v_mfma_f32_32x32x16_bf16 v[236:251], v[36:39], v[20:23], 0
    ds_read_b64_tr_b16 v[36:37], v8 offset:4096
    ds_read_b64_tr_b16 v[38:39], v8 offset:4352
    s_waitcnt lgkmcnt(6)
    v_mfma_f32_32x32x16_bf16 v[236:251], v[40:43], v[24:27], v[236:251]
    ds_write_b32 v11, v52 offset:1536
    s_mov_b64 exec, 1
    ds_add_u32 v118, v119 offset:2848
    s_mov_b64 exec, -1
    ds_read_b64_tr_b16 v[40:41], v8 offset:5120
    ds_read_b64_tr_b16 v[42:43], v8 offset:5376
    s_waitcnt lgkmcnt(8)
    v_mfma_f32_32x32x16_bf16 v[236:251], v[44:47], v[28:31], v[236:251]
    ds_read_b64_tr_b16 v[44:45], v8 offset:6144
    ds_read_b64_tr_b16 v[46:47], v8 offset:6400
    s_waitcnt lgkmcnt(8)
    v_mfma_f32_32x32x16_bf16 v[236:251], v[48:51], v[32:35], v[236:251]
    ds_read_b64_tr_b16 v[48:49], v8 offset:7168
    ds_read_b64_tr_b16 v[50:51], v8 offset:7424
    s_waitcnt lgkmcnt(8)
    v_mfma_f32_32x32x16_bf16 v[236:251], v[36:39], v[68:71], v[236:251]
    ds_read_b64_tr_b16 v[36:37], v8 offset:8192
    ds_read_b64_tr_b16 v[38:39], v8 offset:8448
    s_waitcnt lgkmcnt(6)
    v_mfma_f32_32x32x16_bf16 v[236:251], v[40:43], v[72:75], v[236:251]
    ds_read_b64_tr_b16 v[40:41], v8 offset:9216
    ds_read_b64_tr_b16 v[42:43], v8 offset:9472
    s_waitcnt lgkmcnt(6)
    v_mfma_f32_32x32x16_bf16 v[236:251], v[44:47], v[76:79], v[236:251]
    ds_read_b64_tr_b16 v[44:45], v8 offset:10240
    ds_read_b64_tr_b16 v[46:47], v8 offset:10496
    s_waitcnt lgkmcnt(6)
    v_mfma_f32_32x32x16_bf16 v[236:251], v[48:51], v[80:83], v[236:251]
    ds_read_b64_tr_b16 v[48:49], v8 offset:11264
    ds_read_b64_tr_b16 v[50:51], v8 offset:11520
    s_waitcnt lgkmcnt(6)
    v_mfma_f32_32x32x16_bf16 v[236:251], v[36:39], v[84:87], v[236:251]
    ds_read_b64_tr_b16 v[36:37], v8 offset:12288
    ds_read_b64_tr_b16 v[38:39], v8 offset:12544
    s_waitcnt lgkmcnt(6)
    v_mfma_f32_32x32x16_bf16 v[236:251], v[40:43], v[88:91], v[236:251]
    ds_read_b64_tr_b16 v[40:41], v8 offset:13312
    ds_read_b64_tr_b16 v[42:43], v8 offset:13568
    s_waitcnt lgkmcnt(6)
    v_mfma_f32_32x32x16_bf16 v[236:251], v[44:47], v[92:95], v[236:251]
    ds_read_b64_tr_b16 v[44:45], v8 offset:14336
    ds_read_b64_tr_b16 v[46:47], v8 offset:14592
    s_waitcnt lgkmcnt(6)
    v_mfma_f32_32x32x16_bf16 v[236:251], v[48:51], v[96:99], v[236:251]
    ds_read_b64_tr_b16 v[48:49], v8 offset:15360
    ds_read_b64_tr_b16 v[50:51], v8 offset:15616
    s_waitcnt lgkmcnt(6)
    v_mfma_f32_32x32x16_bf16 v[236:251], v[36:39], v[120:123], v[236:251]
    ds_read_b64_tr_b16 v[36:37], v8 offset:16384
    ds_read_b64_tr_b16 v[38:39], v8 offset:16640
    s_waitcnt lgkmcnt(6)
    v_mfma_f32_32x32x16_bf16 v[236:251], v[40:43], v[124:127], v[236:251]
    ds_read_b64_tr_b16 v[40:41], v8 offset:17408
    ds_read_b64_tr_b16 v[42:43], v8 offset:17664
    s_waitcnt lgkmcnt(6)
    v_mfma_f32_32x32x16_bf16 v[236:251], v[44:47], v[128:131], v[236:251]
    ds_read_b64_tr_b16 v[44:45], v8 offset:18432
    ds_read_b64_tr_b16 v[46:47], v8 offset:18688
    s_waitcnt lgkmcnt(6)
    v_mfma_f32_32x32x16_bf16 v[236:251], v[48:51], v[132:135], v[236:251]
    ds_read_b64_tr_b16 v[48:49], v8 offset:19456
    ds_read_b64_tr_b16 v[50:51], v8 offset:19712
    s_waitcnt lgkmcnt(6)
    v_mfma_f32_32x32x16_bf16 v[236:251], v[36:39], v[136:139], v[236:251]
    ds_read_b64_tr_b16 v[36:37], v8 offset:20480
    ds_read_b64_tr_b16 v[38:39], v8 offset:20736
    s_waitcnt lgkmcnt(6)
    v_mfma_f32_32x32x16_bf16 v[236:251], v[40:43], v[140:143], v[236:251]
    ds_read_b32 v13, v118 offset:2848
    s_waitcnt lgkmcnt(0)
    v_cmp_gt_u32 vcc, 4, v13
    s_cbranch_vccnz L_lwx_4
L_lw_3:
    ds_read_b64_tr_b16 v[40:41], v8 offset:21504
    ds_read_b64_tr_b16 v[42:43], v8 offset:21760
    v_mfma_f32_32x32x16_bf16 v[236:251], v[44:47], v[144:147], v[236:251]
    ds_read_b128 v[52:55], v12 offset:1536
    ds_read_b128 v[56:59], v12 offset:1568
    ds_read_b128 v[60:63], v12 offset:1600
    ds_read_b128 v[64:67], v12 offset:1632
    ds_read_b64_tr_b16 v[44:45], v8 offset:22528
    ds_read_b64_tr_b16 v[46:47], v8 offset:22784
    v_mfma_f32_32x32x16_bf16 v[236:251], v[48:51], v[148:151], v[236:251]
    ds_read_b64_tr_b16 v[48:49], v8 offset:23552
    ds_read_b64_tr_b16 v[50:51], v8 offset:23808
    v_mfma_f32_32x32x16_bf16 v[236:251], v[36:39], v[152:155], v[236:251]
    ds_read_b128 v[68:71], v12 offset:1664
    ds_read_b128 v[72:75], v12 offset:1696
    ds_read_b128 v[76:79], v12 offset:1728
    ds_read_b128 v[80:83], v12 offset:1760
    ds_read_b64_tr_b16 v[36:37], v8 offset:24576
    s_waitcnt lgkmcnt(14)
    ds_read_b64_tr_b16 v[38:39], v8 offset:24832
    s_waitcnt lgkmcnt(14)
    v_mfma_f32_32x32x16_bf16 v[236:251], v[40:43], v[156:159], v[236:251]
    ds_read_b64_tr_b16 v[40:41], v8 offset:25600
    s_waitcnt lgkmcnt(14)
    ds_read_b64_tr_b16 v[42:43], v8 offset:25856
    s_waitcnt lgkmcnt(10)
    v_mfma_f32_32x32x16_bf16 v[236:251], v[44:47], v[196:199], v[236:251]
    ds_read_b128 v[84:87], v12 offset:1792
    ds_read_b128 v[88:91], v12 offset:1824
    ds_read_b128 v[92:95], v12 offset:1856
    ds_read_b128 v[96:99], v12 offset:1888
    s_waitcnt lgkmcnt(8)
    v_add_f32 v52, v52, v68
    v_add_f32 v53, v53, v69
    v_add_f32 v54, v54, v70
    v_add_f32 v55, v55, v71
    v_add_f32 v56, v56, v72
    v_add_f32 v57, v57, v73
    v_add_f32 v58, v58, v74
    v_add_f32 v59, v59, v75
    v_add_f32 v60, v60, v76
    v_add_f32 v61, v61, v77
    v_add_f32 v62, v62, v78
    v_add_f32 v63, v63, v79
    v_add_f32 v64, v64, v80
    v_add_f32 v65, v65, v81
    v_add_f32 v66, v66, v82
    v_add_f32 v67, v67, v83
    ds_read_b64_tr_b16 v[44:45], v8 offset:26624
    ds_read_b64_tr_b16 v[46:47], v8 offset:26880
    v_mfma_f32_32x32x16_bf16 v[236:251], v[48:51], v[200:203], v[236:251]
    ds_read_b64_tr_b16 v[48:49], v8 offset:27648
    ds_read_b64_tr_b16 v[50:51], v8 offset:27904
    s_waitcnt lgkmcnt(10)
    v_mfma_f32_32x32x16_bf16 v[236:251], v[36:39], v[204:207], v[236:251]
    ds_read_b128 v[68:71], v12 offset:1920
    ds_read_b128 v[72:75], v12 offset:1952
    ds_read_b128 v[76:79], v12 offset:1984
    ds_read_b128 v[80:83], v12 offset:2016
    s_waitcnt lgkmcnt(8)
    v_add_f32 v52, v52, v84
    v_add_f32 v53, v53, v85
    v_add_f32 v54, v54, v86
    v_add_f32 v55, v55, v87
    v_add_f32 v56, v56, v88
    v_add_f32 v57, v57, v89
    v_add_f32 v58, v58, v90
    v_add_f32 v59, v59, v91
    v_add_f32 v60, v60, v92
    v_add_f32 v61, v61, v93
    v_add_f32 v62, v62, v94
    v_add_f32 v63, v63, v95
    v_add_f32 v64, v64, v96
    v_add_f32 v65, v65, v97
    v_add_f32 v66, v66, v98
    v_add_f32 v67, v67, v99
    ds_read_b64_tr_b16 v[36:37], v8 offset:28672
    ds_read_b64_tr_b16 v[38:39], v8 offset:28928
    v_mfma_f32_32x32x16_bf16 v[236:251], v[40:43], v[208:211], v[236:251]
    ds_read_b64_tr_b16 v[40:41], v8 offset:29696
    ds_read_b64_tr_b16 v[42:43], v8 offset:29952
    s_waitcnt lgkmcnt(10)
    v_mfma_f32_32x32x16_bf16 v[236:251], v[44:47], v[212:215], v[236:251]
    s_waitcnt lgkmcnt(4)
    v_add_f32 v52, v52, v68
    v_add_f32 v53, v53, v69
    v_add_f32 v54, v54, v70
    v_add_f32 v55, v55, v71
    v_add_f32 v56, v56, v72
    v_add_f32 v57, v57, v73
    v_add_f32 v58, v58, v74
    v_add_f32 v59, v59, v75
    v_add_f32 v60, v60, v76
    v_add_f32 v61, v61, v77
    v_add_f32 v62, v62, v78
    v_add_f32 v63, v63, v79
    v_add_f32 v64, v64, v80
    v_add_f32 v65, v65, v81
    v_add_f32 v66, v66, v82
    v_add_f32 v67, v67, v83
    ds_read_b64_tr_b16 v[44:45], v8 offset:30720
    ds_read_b64_tr_b16 v[46:47], v8 offset:30976
    v_mfma_f32_32x32x16_bf16 v[236:251], v[48:51], v[216:219], v[236:251]
    ds_read_b64_tr_b16 v[48:49], v8 offset:31744
    ds_read_b64_tr_b16 v[50:51], v8 offset:32000
    s_waitcnt lgkmcnt(6)
    v_mfma_f32_32x32x16_bf16 v[236:251], v[36:39], v[220:223], v[236:251]
    s_waitcnt lgkmcnt(4)
    v_mfma_f32_32x32x16_bf16 v[236:251], v[40:43], v[224:227], v[236:251]
    s_waitcnt lgkmcnt(2)
    v_mfma_f32_32x32x16_bf16 v[236:251], v[44:47], v[228:231], v[236:251]
    s_waitcnt lgkmcnt(0)
    v_mfma_f32_32x32x16_bf16 v[236:251], v[48:51], v[232:235], v[236:251]
    v_mul_f32 v108, 0x3eb8aa3b, v108
    v_mul_f32 v109, 0x3eb8aa3b, v109
    v_mul_f32 v52, v109, v52
    v_mul_f32 v53, v109, v53
    v_mul_f32 v54, v109, v54
    v_mul_f32 v55, v109, v55
    v_mul_f32 v56, v109, v56
    v_mul_f32 v57, v109, v57
    v_mul_f32 v58, v109, v58
    v_mul_f32 v59, v109, v59
    v_mul_f32 v60, v109, v60
    v_mul_f32 v61, v109, v61
    v_mul_f32 v62, v109, v62
    v_mul_f32 v63, v109, v63
    v_mul_f32 v64, v109, v64
    v_mul_f32 v65, v109, v65
    v_mul_f32 v66, v109, v66
    v_mul_f32 v67, v109, v67
    s_lshl_b32 s55, s51, 10
    s_add_u32 s55, s55, 151552
    v_add_u32 v14, s55, v2
    v_fma_f32 v236, v236, v108, -v52
    v_fma_f32 v237, v237, v108, -v53
    v_fma_f32 v238, v238, v108, -v54
    v_fma_f32 v239, v239, v108, -v55
    v_fma_f32 v240, v240, v108, -v56
    v_fma_f32 v241, v241, v108, -v57
    v_fma_f32 v242, v242, v108, -v58
    v_fma_f32 v243, v243, v108, -v59
    v_fma_f32 v244, v244, v108, -v60
    v_fma_f32 v245, v245, v108, -v61
    v_fma_f32 v246, v246, v108, -v62
    v_fma_f32 v247, v247, v108, -v63
    v_fma_f32 v248, v248, v108, -v64
    v_fma_f32 v249, v249, v108, -v65
    v_fma_f32 v250, v250, v108, -v66
    v_fma_f32 v251, v251, v108, -v67
    v_cvt_pk_bf16_f32 v40, v236, v237
    v_cvt_pk_bf16_f32 v41, v238, v239
    v_cvt_pk_bf16_f32 v42, v240, v241
    v_cvt_pk_bf16_f32 v43, v242, v243
    ds_write_b128 v14, v[40:43]
    v_cvt_pk_bf16_f32 v160, v244, v245
    v_cvt_pk_bf16_f32 v161, v246, v247
    v_cvt_pk_bf16_f32 v162, v248, v249
    v_cvt_pk_bf16_f32 v163, v250, v251
    s_mov_b64 exec, 1
    ds_add_u32 v118, v119 offset:2852
    s_mov_b64 exec, -1
    ds_read_b32 v12, v118 offset:2856
    s_waitcnt lgkmcnt(0)
    v_cmp_gt_u32 vcc, 4, v12
    s_cbranch_vccnz L_lwx_6
L_lw_5:
    s_lshl_b32 s61, s63, 14
    s_add_u32 m0, s61, 3072
    s_lshl_b32 s61, s63, 17
    s_add_u32 s61, s61, 0
    buffer_load_dwordx4 v115, s[12:15], s61 offen lds
    s_lshl_b32 s61, s63, 14
    s_add_u32 m0, s61, 4096
    s_lshl_b32 s61, s63, 17
    s_add_u32 s61, s61, 8192
    buffer_load_dwordx4 v115, s[12:15], s61 offen lds
    s_lshl_b32 s61, s63, 14
    s_add_u32 m0, s61, 5120
    s_lshl_b32 s61, s63, 17
    s_add_u32 s61, s61, 16384
    buffer_load_dwordx4 v115, s[12:15], s61 offen lds
    s_lshl_b32 s61, s63, 14
    s_add_u32 m0, s61, 6144
    s_lshl_b32 s61, s63, 17
    s_add_u32 s61, s61, 24576
    buffer_load_dwordx4 v115, s[12:15], s61 offen lds
    s_lshl_b32 s61, s63, 14
    s_add_u32 m0, s61, 7168
    s_lshl_b32 s61, s63, 17
    s_add_u32 s61, s61, 32768
    buffer_load_dwordx4 v115, s[12:15], s61 offen lds
    s_lshl_b32 s61, s63, 14
    s_add_u32 m0, s61, 8192
    s_lshl_b32 s61, s63, 17
    s_add_u32 s61, s61, 40960
    buffer_load_dwordx4 v115, s[12:15], s61 offen lds
    s_lshl_b32 s61, s63, 14
    s_add_u32 m0, s61, 9216
    s_lshl_b32 s61, s63, 17
    s_add_u32 s61, s61, 49152
    buffer_load_dwordx4 v115, s[12:15], s61 offen lds
    s_lshl_b32 s61, s63, 14
    s_add_u32 m0, s61, 10240
    s_lshl_b32 s61, s63, 17
    s_add_u32 s61, s61, 57344
    buffer_load_dwordx4 v115, s[12:15], s61 offen lds
    s_lshl_b32 s61, s63, 14
    s_add_u32 m0, s61, 11264
    s_lshl_b32 s61, s63, 17
    s_add_u32 s61, s61, 65536
    buffer_load_dwordx4 v115, s[12:15], s61 offen lds
    s_lshl_b32 s61, s63, 14
    s_add_u32 m0, s61, 12288
    s_lshl_b32 s61, s63, 17
    s_add_u32 s61, s61, 73728
    buffer_load_dwordx4 v115, s[12:15], s61 offen lds
    s_lshl_b32 s61, s63, 14
    s_add_u32 m0, s61, 13312
    s_lshl_b32 s61, s63, 17
    s_add_u32 s61, s61, 81920
    buffer_load_dwordx4 v115, s[12:15], s61 offen lds
    s_lshl_b32 s61, s63, 14
    s_add_u32 m0, s61, 14336
    s_lshl_b32 s61, s63, 17
    s_add_u32 s61, s61, 90112
    buffer_load_dwordx4 v115, s[12:15], s61 offen lds
    s_lshl_b32 s61, s63, 14
    s_add_u32 m0, s61, 15360
    s_lshl_b32 s61, s63, 17
    s_add_u32 s61, s61, 98304
    buffer_load_dwordx4 v115, s[12:15], s61 offen lds
    s_lshl_b32 s61, s63, 14
    s_add_u32 m0, s61, 16384
    s_lshl_b32 s61, s63, 17
    s_add_u32 s61, s61, 106496
    buffer_load_dwordx4 v115, s[12:15], s61 offen lds
    s_lshl_b32 s61, s63, 14
    s_add_u32 m0, s61, 17408
    s_lshl_b32 s61, s63, 17
    s_add_u32 s61, s61, 114688
    buffer_load_dwordx4 v115, s[12:15], s61 offen lds
    s_lshl_b32 s61, s63, 14
    s_add_u32 m0, s61, 18432
    s_lshl_b32 s61, s63, 17
    s_add_u32 s61, s61, 122880
    buffer_load_dwordx4 v115, s[12:15], s61 offen lds
    ds_read_b128 v[60:63], v100 offset:16384
    ds_read_b128 v[68:71], v101 offset:16640
    ds_read_b128 v[72:75], v101 offset:17680
    s_waitcnt lgkmcnt(2)
    v_mfma_f32_32x32x16_bf16 v[20:35], v[60:63], v[160:163], v[164:179]
    ds_read_b128 v[64:67], v100 offset:14336
    ds_read_b128 v[76:79], v101 offset:14560
    ds_read_b128 v[80:83], v101 offset:15600
    s_nop 8
    v_exp_f32 v20, v20
    v_exp_f32 v21, v21
    v_exp_f32 v22, v22
    v_exp_f32 v23, v23
    v_exp_f32 v24, v24
    v_exp_f32 v25, v25
    v_exp_f32 v26, v26
    v_exp_f32 v27, v27
    s_waitcnt lgkmcnt(2)
    v_mfma_f32_32x32x16_bf16 v[36:51], v[64:67], v[160:163], 0
    v_cvt_pk_bf16_f32 v52, v20, v21
    v_cvt_pk_bf16_f32 v53, v22, v23
    v_cvt_pk_bf16_f32 v54, v24, v25
    v_cvt_pk_bf16_f32 v55, v26, v27
    s_nop 1
    v_mfma_f32_32x32x16_bf16 v[84:99], v[68:71], v[52:55], 0
    v_exp_f32 v28, v28
    v_exp_f32 v29, v29
    v_exp_f32 v30, v30
    v_exp_f32 v31, v31
    v_exp_f32 v32, v32
    v_exp_f32 v33, v33
    v_exp_f32 v34, v34
    v_exp_f32 v35, v35
    v_cvt_pk_bf16_f32 v56, v28, v29
    v_cvt_pk_bf16_f32 v57, v30, v31
    v_cvt_pk_bf16_f32 v58, v32, v33
    v_cvt_pk_bf16_f32 v59, v34, v35
    s_nop 1
    v_mfma_f32_32x32x16_bf16 v[84:99], v[72:75], v[56:59], v[84:99]
    s_cmp_eq_u32 s51, 0
    s_cbranch_scc1 L_2a_done_7
    ds_read_b128 v[60:63], v100 offset:12288
    ds_read_b128 v[68:71], v101 offset:12480
    ds_read_b128 v[72:75], v101 offset:13520
    v_exp_f32 v36, v36
    v_exp_f32 v37, v37
    v_exp_f32 v38, v38
    v_exp_f32 v39, v39
    v_exp_f32 v40, v40
    v_exp_f32 v41, v41
    v_exp_f32 v42, v42
    v_exp_f32 v43, v43
    s_waitcnt lgkmcnt(2)
    v_mfma_f32_32x32x16_bf16 v[20:35], v[60:63], v[160:163], 0
    v_cvt_pk_bf16_f32 v52, v36, v37
    v_cvt_pk_bf16_f32 v53, v38, v39
    v_cvt_pk_bf16_f32 v54, v40, v41
    v_cvt_pk_bf16_f32 v55, v42, v43
    s_nop 1
    v_mfma_f32_32x32x16_bf16 v[84:99], v[76:79], v[52:55], v[84:99]
    v_exp_f32 v44, v44
    v_exp_f32 v45, v45
    v_exp_f32 v46, v46
    v_exp_f32 v47, v47
    v_exp_f32 v48, v48
    v_exp_f32 v49, v49
    v_exp_f32 v50, v50
    v_exp_f32 v51, v51
    v_cvt_pk_bf16_f32 v56, v44, v45
    v_cvt_pk_bf16_f32 v57, v46, v47
    v_cvt_pk_bf16_f32 v58, v48, v49
    v_cvt_pk_bf16_f32 v59, v50, v51
    s_nop 1
    v_mfma_f32_32x32x16_bf16 v[84:99], v[80:83], v[56:59], v[84:99]
    s_cmp_eq_u32 s51, 1
    s_cbranch_scc1 L_2a_done_7
    ds_read_b128 v[64:67], v100 offset:10240
    ds_read_b128 v[76:79], v101 offset:10400
    ds_read_b128 v[80:83], v101 offset:11440
    v_exp_f32 v20, v20
    v_exp_f32 v21, v21
    v_exp_f32 v22, v22
    v_exp_f32 v23, v23
    v_exp_f32 v24, v24
    v_exp_f32 v25, v25
    v_exp_f32 v26, v26
    v_exp_f32 v27, v27
    s_waitcnt lgkmcnt(2)
    v_mfma_f32_32x32x16_bf16 v[36:51], v[64:67], v[160:163], 0
    v_cvt_pk_bf16_f32 v52, v20, v21
    v_cvt_pk_bf16_f32 v53, v22, v23
    v_cvt_pk_bf16_f32 v54, v24, v25
    v_cvt_pk_bf16_f32 v55, v26, v27
    s_nop 1
    v_mfma_f32_32x32x16_bf16 v[84:99], v[68:71], v[52:55], v[84:99]
    v_exp_f32 v28, v28
    v_exp_f32 v29, v29
    v_exp_f32 v30, v30
    v_exp_f32 v31, v31
    v_exp_f32 v32, v32
    v_exp_f32 v33, v33
    v_exp_f32 v34, v34
    v_exp_f32 v35, v35
    v_cvt_pk_bf16_f32 v56, v28, v29
    v_cvt_pk_bf16_f32 v57, v30, v31
    v_cvt_pk_bf16_f32 v58, v32, v33
    v_cvt_pk_bf16_f32 v59, v34, v35
    s_nop 1
    v_mfma_f32_32x32x16_bf16 v[84:99], v[72:75], v[56:59], v[84:99]
    s_cmp_eq_u32 s51, 2
    s_cbranch_scc1 L_2a_done_7
    v_exp_f32 v36, v36
    v_exp_f32 v37, v37
    v_exp_f32 v38, v38
    v_exp_f32 v39, v39
    v_exp_f32 v40, v40
    v_exp_f32 v41, v41
    v_exp_f32 v42, v42
    v_exp_f32 v43, v43
    v_cvt_pk_bf16_f32 v52, v36, v37
    v_cvt_pk_bf16_f32 v53, v38, v39
    v_cvt_pk_bf16_f32 v54, v40, v41
    v_cvt_pk_bf16_f32 v55, v42, v43
    s_waitcnt lgkmcnt(0)
    s_nop 0
    v_mfma_f32_32x32x16_bf16 v[84:99], v[76:79], v[52:55], v[84:99]
    v_exp_f32 v44, v44
    v_exp_f32 v45, v45
    v_exp_f32 v46, v46
    v_exp_f32 v47, v47
    v_exp_f32 v48, v48
    v_exp_f32 v49, v49
    v_exp_f32 v50, v50
    v_exp_f32 v51, v51
    v_cvt_pk_bf16_f32 v56, v44, v45
    v_cvt_pk_bf16_f32 v57, v46, v47
    v_cvt_pk_bf16_f32 v58, v48, v49
    v_cvt_pk_bf16_f32 v59, v50, v51
    s_nop 1
    v_mfma_f32_32x32x16_bf16 v[84:99], v[80:83], v[56:59], v[84:99]
L_2a_done_7:
    s_waitcnt lgkmcnt(0)
    s_barrier
    v_mov_b32 v10, 2564
    ds_read_b32 v10, v10
    s_waitcnt lgkmcnt(0)
    v_readfirstlane_b32 s53, v10
    s_setprio 1
    s_max_i32 s55, s46, 1
    s_sub_u32 s55, s55, 1
    s_lshl_b32 s55, s55, 4
    s_add_u32 s55, s55, s47
    s_lshl_b32 s55, s55, 7
    s_add_u32 s55, s55, 8208
    v_and_b32 v102, 3, v1
    v_lshlrev_b32 v102, 2, v102
    v_add_u32 v102, s55, v102
    ds_read_b128 v[60:63], v100 offset:0
    ds_read_b128 v[68:71], v101 offset:0
    ds_read_b128 v[72:75], v101 offset:1040
    s_waitcnt lgkmcnt(2)
    v_mfma_f32_32x32x16_bf16 v[20:35], v[60:63], v[160:163], v[180:195]
    ds_read_b128 v[64:67], v100 offset:2048
    ds_read_b128 v[76:79], v101 offset:2080
    ds_read_b128 v[80:83], v101 offset:3120
    s_nop 8
    v_exp_f32 v20, v20
    s_mul_i32 s61, s63, 352256
    s_add_u32 s61, s61, 0
    buffer_load_dwordx4 v[120:123], v112, s[16:19], s61 offen
    v_exp_f32 v21, v21
    v_exp_f32 v22, v22
    buffer_load_dwordx4 v[124:127], v113, s[16:19], s61 offen
    v_exp_f32 v23, v23
    v_exp_f32 v24, v24
    v_exp_f32 v25, v25
    buffer_load_dwordx4 v[128:131], v114, s[16:19], s61 offen
    v_exp_f32 v26, v26
    v_exp_f32 v27, v27
    s_waitcnt lgkmcnt(2)
    v_mfma_f32_32x32x16_bf16 v[36:51], v[64:67], v[160:163], 0
    v_cvt_pk_bf16_f32 v52, v20, v21
    v_cvt_pk_bf16_f32 v53, v22, v23
    v_cvt_pk_bf16_f32 v54, v24, v25
    v_cvt_pk_bf16_f32 v55, v26, v27
    s_nop 1
    v_mfma_f32_32x32x16_bf16 v[84:99], v[68:71], v[52:55], v[84:99]
    v_exp_f32 v28, v28
    s_mul_i32 s61, s63, 352256
    s_add_u32 s61, s61, 44032
    buffer_load_dwordx4 v[132:135], v112, s[16:19], s61 offen
    v_exp_f32 v29, v29
    v_exp_f32 v30, v30
    v_exp_f32 v31, v31
    buffer_load_dwordx4 v[136:139], v113, s[16:19], s61 offen
    v_exp_f32 v32, v32
    v_exp_f32 v33, v33
    buffer_load_dwordx4 v[140:143], v114, s[16:19], s61 offen
    v_exp_f32 v34, v34
    v_exp_f32 v35, v35
    v_cvt_pk_bf16_f32 v56, v28, v29
    v_cvt_pk_bf16_f32 v57, v30, v31
    v_cvt_pk_bf16_f32 v58, v32, v33
    v_cvt_pk_bf16_f32 v59, v34, v35
    s_nop 1
    v_mfma_f32_32x32x16_bf16 v[84:99], v[72:75], v[56:59], v[84:99]
    ds_read_b128 v[60:63], v100 offset:4096
    ds_read_b128 v[68:71], v101 offset:4160
    ds_read_b128 v[72:75], v101 offset:5200
    v_exp_f32 v36, v36
    s_mul_i32 s61, s63, 352256
    s_add_u32 s61, s61, 88064
    buffer_load_dwordx4 v[144:147], v112, s[16:19], s61 offen
    v_exp_f32 v37, v37
    v_exp_f32 v38, v38
    v_exp_f32 v39, v39
    buffer_load_dwordx4 v[148:151], v113, s[16:19], s61 offen
    v_exp_f32 v40, v40
    v_exp_f32 v41, v41
    v_exp_f32 v42, v42
    v_exp_f32 v43, v43
    s_waitcnt vmcnt(8)
    s_mov_b64 exec, 1
    ds_add_u32 v118, v119 offset:2836
    s_mov_b64 exec, -1
    s_waitcnt lgkmcnt(3)
    v_mfma_f32_32x32x16_bf16 v[20:35], v[60:63], v[160:163], 0
    v_cvt_pk_bf16_f32 v52, v36, v37
    v_cvt_pk_bf16_f32 v53, v38, v39
    v_cvt_pk_bf16_f32 v54, v40, v41
    v_cvt_pk_bf16_f32 v55, v42, v43
    s_nop 1
    v_mfma_f32_32x32x16_bf16 v[84:99], v[76:79], v[52:55], v[84:99]
    v_exp_f32 v44, v44
    buffer_load_dwordx4 v[152:155], v114, s[16:19], s61 offen
    v_exp_f32 v45, v45
    v_exp_f32 v46, v46
    v_exp_f32 v47, v47
    s_mul_i32 s61, s63, 352256
    s_add_u32 s61, s61, 132096
    buffer_load_dwordx4 v[156:159], v112, s[16:19], s61 offen
    v_exp_f32 v48, v48
    v_exp_f32 v49, v49
    v_exp_f32 v50, v50
    v_exp_f32 v51, v51
    buffer_load_dwordx4 v[196:199], v113, s[16:19], s61 offen
    v_cvt_pk_bf16_f32 v56, v44, v45
    v_cvt_pk_bf16_f32 v57, v46, v47
    v_cvt_pk_bf16_f32 v58, v48, v49
    v_cvt_pk_bf16_f32 v59, v50, v51
    s_nop 1
    v_mfma_f32_32x32x16_bf16 v[84:99], v[80:83], v[56:59], v[84:99]
    ds_read_b128 v[64:67], v100 offset:6144
    ds_read_b128 v[76:79], v101 offset:6240
    ds_read_b128 v[80:83], v101 offset:7280
    v_exp_f32 v20, v20
    v_exp_f32 v21, v21
    v_exp_f32 v22, v22
    buffer_load_dwordx4 v[200:203], v114, s[16:19], s61 offen
    v_exp_f32 v23, v23
    s_mul_i32 s61, s63, 352256
    s_add_u32 s61, s61, 176128
    buffer_load_dwordx4 v[204:207], v112, s[16:19], s61 offen
    v_exp_f32 v24, v24
    v_exp_f32 v25, v25
    v_exp_f32 v26, v26
    v_exp_f32 v27, v27
    buffer_load_dwordx4 v[208:211], v113, s[16:19], s61 offen
    s_waitcnt lgkmcnt(2)
    v_mfma_f32_32x32x16_bf16 v[36:51], v[64:67], v[160:163], 0
    v_cvt_pk_bf16_f32 v52, v20, v21
    v_cvt_pk_bf16_f32 v53, v22, v23
    v_cvt_pk_bf16_f32 v54, v24, v25
    v_cvt_pk_bf16_f32 v55, v26, v27
    s_nop 1
    v_mfma_f32_32x32x16_bf16 v[84:99], v[68:71], v[52:55], v[84:99]
    v_exp_f32 v28, v28
    v_exp_f32 v29, v29
    v_exp_f32 v30, v30
    buffer_load_dwordx4 v[212:215], v114, s[16:19], s61 offen
    v_exp_f32 v31, v31
    v_exp_f32 v32, v32
    v_exp_f32 v33, v33
    s_mul_i32 s61, s63, 352256
    s_add_u32 s61, s61, 220160
    buffer_load_dwordx4 v[216:219], v112, s[16:19], s61 offen
    v_exp_f32 v34, v34
    v_exp_f32 v35, v35
    buffer_load_dwordx4 v[220:223], v113, s[16:19], s61 offen
    v_cvt_pk_bf16_f32 v56, v28, v29
    v_cvt_pk_bf16_f32 v57, v30, v31
    v_cvt_pk_bf16_f32 v58, v32, v33
    v_cvt_pk_bf16_f32 v59, v34, v35
    s_nop 1
    v_mfma_f32_32x32x16_bf16 v[84:99], v[72:75], v[56:59], v[84:99]
    ds_read_b128 v[60:63], v100 offset:8192
    ds_read_b128 v[68:71], v101 offset:8320
    ds_read_b128 v[72:75], v101 offset:9360
    v_exp_f32 v36, v36
    v_exp_f32 v37, v37
    v_exp_f32 v38, v38
    buffer_load_dwordx4 v[224:227], v114, s[16:19], s61 offen
    v_exp_f32 v39, v39
    v_exp_f32 v40, v40
    v_exp_f32 v41, v41
    s_mul_i32 s61, s63, 352256
    s_add_u32 s61, s61, 264192
    buffer_load_dwordx4 v[228:231], v112, s[16:19], s61 offen
    v_exp_f32 v42, v42
    v_exp_f32 v43, v43
    s_waitcnt lgkmcnt(2)
    v_mfma_f32_32x32x16_bf16 v[20:35], v[60:63], v[160:163], 0
    v_cvt_pk_bf16_f32 v52, v36, v37
    v_cvt_pk_bf16_f32 v53, v38, v39
    v_cvt_pk_bf16_f32 v54, v40, v41
    v_cvt_pk_bf16_f32 v55, v42, v43
    s_nop 1
    v_mfma_f32_32x32x16_bf16 v[84:99], v[76:79], v[52:55], v[84:99]
    v_exp_f32 v44, v44
    buffer_load_dwordx4 v[232:235], v113, s[16:19], s61 offen
    v_exp_f32 v45, v45
    v_exp_f32 v46, v46
    buffer_load_dwordx4 v[236:239], v114, s[16:19], s61 offen
    v_exp_f32 v47, v47
    v_exp_f32 v48, v48
    v_exp_f32 v49, v49
    s_mul_i32 s61, s63, 352256
    s_add_u32 s61, s61, 308224
    buffer_load_dwordx4 v[240:243], v112, s[16:19], s61 offen
    v_exp_f32 v50, v50
    v_exp_f32 v51, v51
    v_cvt_pk_bf16_f32 v56, v44, v45
    v_cvt_pk_bf16_f32 v57, v46, v47
    v_cvt_pk_bf16_f32 v58, v48, v49
    v_cvt_pk_bf16_f32 v59, v50, v51
    s_nop 1
    v_mfma_f32_32x32x16_bf16 v[84:99], v[80:83], v[56:59], v[84:99]
    ds_read_b128 v[64:67], v100 offset:10240
    ds_read_b128 v[76:79], v101 offset:10400
    ds_read_b128 v[80:83], v101 offset:11440
    v_exp_f32 v20, v20
    buffer_load_dwordx4 v[244:247], v113, s[16:19], s61 offen
    v_exp_f32 v21, v21
    v_exp_f32 v22, v22
    v_exp_f32 v23, v23
    buffer_load_dwordx4 v[248:251], v114, s[16:19], s61 offen
    v_exp_f32 v24, v24
    v_exp_f32 v25, v25
    v_exp_f32 v26, v26
    v_exp_f32 v27, v27
    buffer_load_dword v103, v102, s[28:31], 0 offen sc1
    s_waitcnt lgkmcnt(2)
    v_mfma_f32_32x32x16_bf16 v[36:51], v[64:67], v[160:163], 0
    v_cvt_pk_bf16_f32 v52, v20, v21
    v_cvt_pk_bf16_f32 v53, v22, v23
    v_cvt_pk_bf16_f32 v54, v24, v25
    v_cvt_pk_bf16_f32 v55, v26, v27
    s_nop 1
    v_mfma_f32_32x32x16_bf16 v[84:99], v[68:71], v[52:55], v[84:99]
    v_exp_f32 v28, v28
    v_exp_f32 v29, v29
    v_exp_f32 v30, v30
    v_exp_f32 v31, v31
    v_exp_f32 v32, v32
    v_exp_f32 v33, v33
    v_exp_f32 v34, v34
    v_exp_f32 v35, v35
    v_cvt_pk_bf16_f32 v56, v28, v29
    v_cvt_pk_bf16_f32 v57, v30, v31
    v_cvt_pk_bf16_f32 v58, v32, v33
    v_cvt_pk_bf16_f32 v59, v34, v35
    s_nop 1
    v_mfma_f32_32x32x16_bf16 v[84:99], v[72:75], v[56:59], v[84:99]
    s_cmp_eq_u32 s51, 3
    s_cbranch_scc1 L_2b_done_8
    ds_read_b128 v[60:63], v100 offset:12288
    ds_read_b128 v[68:71], v101 offset:12480
    ds_read_b128 v[72:75], v101 offset:13520
    v_exp_f32 v36, v36
    v_exp_f32 v37, v37
    v_exp_f32 v38, v38
    v_exp_f32 v39, v39
    v_exp_f32 v40, v40
    v_exp_f32 v41, v41
    v_exp_f32 v42, v42
    v_exp_f32 v43, v43
    s_waitcnt lgkmcnt(2)
    v_mfma_f32_32x32x16_bf16 v[20:35], v[60:63], v[160:163], 0
    v_cvt_pk_bf16_f32 v52, v36, v37
    v_cvt_pk_bf16_f32 v53, v38, v39
    v_cvt_pk_bf16_f32 v54, v40, v41
    v_cvt_pk_bf16_f32 v55, v42, v43
    s_nop 1
    v_mfma_f32_32x32x16_bf16 v[84:99], v[76:79], v[52:55], v[84:99]
    v_exp_f32 v44, v44
    v_exp_f32 v45, v45
    v_exp_f32 v46, v46
    v_exp_f32 v47, v47
    v_exp_f32 v48, v48
    v_exp_f32 v49, v49
    v_exp_f32 v50, v50
    v_exp_f32 v51, v51
    v_cvt_pk_bf16_f32 v56, v44, v45
    v_cvt_pk_bf16_f32 v57, v46, v47
    v_cvt_pk_bf16_f32 v58, v48, v49
    v_cvt_pk_bf16_f32 v59, v50, v51
    s_nop 1
    v_mfma_f32_32x32x16_bf16 v[84:99], v[80:83], v[56:59], v[84:99]
    s_cmp_eq_u32 s51, 2
    s_cbranch_scc1 L_2b_done_8
    ds_read_b128 v[64:67], v100 offset:14336
    ds_read_b128 v[76:79], v101 offset:14560
    ds_read_b128 v[80:83], v101 offset:15600
    v_exp_f32 v20, v20
    v_exp_f32 v21, v21
    v_exp_f32 v22, v22
    v_exp_f32 v23, v23
    v_exp_f32 v24, v24
    v_exp_f32 v25, v25
    v_exp_f32 v26, v26
    v_exp_f32 v27, v27
    s_waitcnt lgkmcnt(2)
    v_mfma_f32_32x32x16_bf16 v[36:51], v[64:67], v[160:163], 0
    v_cvt_pk_bf16_f32 v52, v20, v21
    v_cvt_pk_bf16_f32 v53, v22, v23
    v_cvt_pk_bf16_f32 v54, v24, v25
    v_cvt_pk_bf16_f32 v55, v26, v27
    s_nop 1
    v_mfma_f32_32x32x16_bf16 v[84:99], v[68:71], v[52:55], v[84:99]
    v_exp_f32 v28, v28
    v_exp_f32 v29, v29
    v_exp_f32 v30, v30
    v_exp_f32 v31, v31
    v_exp_f32 v32, v32
    v_exp_f32 v33, v33
    v_exp_f32 v34, v34
    v_exp_f32 v35, v35
    v_cvt_pk_bf16_f32 v56, v28, v29
    v_cvt_pk_bf16_f32 v57, v30, v31
    v_cvt_pk_bf16_f32 v58, v32, v33
    v_cvt_pk_bf16_f32 v59, v34, v35
    s_nop 1
    v_mfma_f32_32x32x16_bf16 v[84:99], v[72:75], v[56:59], v[84:99]
    s_cmp_eq_u32 s51, 1
    s_cbranch_scc1 L_2b_done_8
    v_exp_f32 v36, v36
    v_exp_f32 v37, v37
    v_exp_f32 v38, v38
    v_exp_f32 v39, v39
    v_exp_f32 v40, v40
    v_exp_f32 v41, v41
    v_exp_f32 v42, v42
    v_exp_f32 v43, v43
    v_cvt_pk_bf16_f32 v52, v36, v37
    v_cvt_pk_bf16_f32 v53, v38, v39
    v_cvt_pk_bf16_f32 v54, v40, v41
    v_cvt_pk_bf16_f32 v55, v42, v43
    s_waitcnt lgkmcnt(0)
    s_nop 0
    v_mfma_f32_32x32x16_bf16 v[84:99], v[76:79], v[52:55], v[84:99]
    v_exp_f32 v44, v44
    v_exp_f32 v45, v45
    v_exp_f32 v46, v46
    v_exp_f32 v47, v47
    v_exp_f32 v48, v48
    v_exp_f32 v49, v49
    v_exp_f32 v50, v50
    v_exp_f32 v51, v51
    v_cvt_pk_bf16_f32 v56, v44, v45
    v_cvt_pk_bf16_f32 v57, v46, v47
    v_cvt_pk_bf16_f32 v58, v48, v49
    v_cvt_pk_bf16_f32 v59, v50, v51
    s_nop 1
    v_mfma_f32_32x32x16_bf16 v[84:99], v[80:83], v[56:59], v[84:99]
L_2b_done_8:
    s_waitcnt lgkmcnt(0)
    v_mov_b32 v10, 0x21800000
    v_mov_b32 v11, 0x5d800000
    s_lshl_b32 s55, s46, 2
    s_add_u32 s55, s55, s51
    s_lshl_b32 s55, s55, 5
    s_lshl_b32 s61, s47, 1
    s_add_u32 s55, s55, s61
    s_add_u32 s55, s55, s54
    s_lshl_b32 s62, s55, 2
    s_add_u32 s62, s62, 40960
    s_lshl_b32 s55, s51, 2
    s_add_u32 s55, s55, s54
    s_lshl_b32 s55, s55, 10
    s_add_u32 s61, s55, s88
    v_cmp_nlt_f32 vcc, v10, v92
    v_cmp_nlt_f32 s[56:57], v92, v11
    s_or_b64 vcc, vcc, s[56:57]
    s_cbranch_vccnz L_fb_9
L_fbret_10:
    s_nop 7
    v_rcp_f32 v10, v92
    s_nop 0
    v_mul_f32 v84, v84, v10
    v_mul_f32 v85, v85, v10
    v_mul_f32 v86, v86, v10
    v_mul_f32 v87, v87, v10
    v_mul_f32 v88, v88, v10
    v_mul_f32 v89, v89, v10
    v_mul_f32 v90, v90, v10
    v_mul_f32 v91, v91, v10
    v_cvt_pk_bf16_f32 v12, v84, v85
    v_cvt_pk_bf16_f32 v13, v86, v87
    v_cvt_pk_bf16_f32 v14, v88, v89
    v_cvt_pk_bf16_f32 v15, v90, v91
    s_waitcnt vmcnt(0)
    v_cmp_ne_u32 vcc, s52, v103
    s_cbranch_vccnz L_rdx_12
L_rdc_11:
    s_cmp_eq_u32 s53, 1
    s_cbranch_scc0 L_safe_13
    buffer_store_dwordx4 v[12:15], v2, s[28:31], s61 offen
L_back_14:
    v_mov_b32 v10, s62
    v_mov_b32 v11, s52
    s_waitcnt vmcnt(0)
    s_mov_b64 exec, 1
    s_cmp_eq_u32 s53, 1
    s_cbranch_scc0 L_safe_15
    buffer_store_dword v11, v10, s[28:31], 0 offen
L_back_16:
    s_mov_b64 exec, -1
    s_setprio 0
    v_min_u32 v10, 47, v1
    v_lshlrev_b32 v11, 2, v10
    s_mul_i32 s55, s47, 192
    buffer_load_dword v12, v11, s[32:35], s55 offen
    s_mul_i32 s55, s63, 24576
    s_add_u32 s55, s55, 3072
    v_add_u32 v3, s55, v2
    s_barrier
    ds_write_b128 v3, v[120:123] offset:0
    ds_write_b128 v3, v[124:127] offset:1024
    ds_write_b128 v3, v[128:131] offset:2048
    ds_write_b128 v3, v[132:135] offset:3072
    s_waitcnt lgkmcnt(4)
    ds_write_b128 v3, v[136:139] offset:4096
    ds_write_b128 v3, v[140:143] offset:5120
    ds_write_b128 v3, v[144:147] offset:6144
    ds_write_b128 v3, v[148:151] offset:7168
    s_waitcnt lgkmcnt(4)
    ds_write_b128 v3, v[152:155] offset:8192
    ds_write_b128 v3, v[156:159] offset:9216
    ds_write_b128 v3, v[196:199] offset:10240
    ds_write_b128 v3, v[200:203] offset:11264
    s_waitcnt lgkmcnt(4)
    ds_write_b128 v3, v[204:207] offset:12288
    ds_write_b128 v3, v[208:211] offset:13312
    ds_write_b128 v3, v[212:215] offset:14336
    ds_write_b128 v3, v[216:219] offset:15360
    s_waitcnt lgkmcnt(4)
    ds_write_b128 v3, v[220:223] offset:16384
    ds_write_b128 v3, v[224:227] offset:17408
    ds_write_b128 v3, v[228:231] offset:18432
    ds_write_b128 v3, v[232:235] offset:19456
    s_waitcnt lgkmcnt(4)
    ds_write_b128 v3, v[236:239] offset:20480
    ds_write_b128 v3, v[240:243] offset:21504
    ds_write_b128 v3, v[244:247] offset:22528
    ds_write_b128 v3, v[248:251] offset:23552
    s_waitcnt lgkmcnt(4)
    s_waitcnt vmcnt(0)
    v_lshlrev_b32 v14, 16, v12
    v_and_b32 v15, 0xffff0000, v12
    v_lshlrev_b32 v11, 3, v10
    ds_write_b64 v11, v[14:15] offset:2048
    v_mov_b32 v16, 0
    v_mov_b32 v17, 1
    s_mov_b64 exec, 1
    ds_add_u32 v16, v17 offset:2868
    s_mov_b64 exec, -1
    v_bfe_u32 v10, v1, 2, 2
    v_lshrrev_b32 v11, 5, v1
    v_lshl_add_u32 v10, v11, 2, v10
    v_mul_u32_u24 v10, 192, v10
    v_bfe_u32 v11, v1, 4, 1
    v_lshl_add_u32 v10, v11, 5, v10
    v_and_b32 v11, 3, v1
    v_lshl_add_u32 v3, v11, 3, v10
    s_min_u32 s56, s63, 2
    s_lshl_b32 s56, s56, 6
    v_add_u32 v3, s56, v3
    v_add_u32 v4, 0x10000, v3
    v_mov_b32 v18, 0x3f803f80
    v_mov_b32 v100, 0
    v_mov_b32 v101, 0
    ds_read_b32 v10, v16 offset:2840
    s_waitcnt lgkmcnt(0)
    v_cmp_gt_u32 vcc, 4, v10
    s_cbranch_vccnz L_lwx_18
L_lw_17:
    s_mov_b32 s61, 65536
    s_cmp_eq_u32 s63, 1
    s_cselect_b32 s61, 81920, s61
    s_cmp_eq_u32 s63, 2
    s_cselect_b32 s61, 163840, s61
    s_cmp_eq_u32 s63, 3
    s_cselect_b32 s61, 180224, s61
    s_mul_i32 s62, s63, 2048
    s_add_u32 s62, s62, 101376
    s_mov_b32 m0, s62
    s_nop 0
    buffer_load_dwordx4 v115, s[20:23], s61 offen lds
    s_add_u32 s61, s61, 8192
    s_add_u32 m0, s62, 1024
    s_nop 0
    buffer_load_dwordx4 v115, s[20:23], s61 offen lds
    s_mov_b32 s61, 753664
    s_cmp_eq_u32 s63, 1
    s_cselect_b32 s61, 770048, s61
    s_cmp_eq_u32 s63, 2
    s_cselect_b32 s61, 851968, s61
    s_cmp_eq_u32 s63, 3
    s_cselect_b32 s61, 868352, s61
    s_mul_i32 s62, s63, 2048
    s_add_u32 s62, s62, 109568
    s_mov_b32 m0, s62
    s_nop 0
    buffer_load_dwordx4 v115, s[20:23], s61 offen lds
    s_add_u32 s61, s61, 8192
    s_add_u32 m0, s62, 1024
    s_nop 0
    buffer_load_dwordx4 v115, s[20:23], s61 offen lds
    s_mov_b32 s61, 16384
    s_cmp_eq_u32 s63, 1
    s_cselect_b32 s61, 704512, s61
    s_cmp_eq_u32 s63, 2
    s_cselect_b32 s61, 32768, s61
    s_cmp_eq_u32 s63, 3
    s_cselect_b32 s61, 720896, s61
    buffer_load_dwordx4 v[120:123], v115, s[20:23], s61 offen
    s_add_u32 s61, s61, 8192
    buffer_load_dwordx4 v[124:127], v115, s[20:23], s61 offen
    s_mov_b32 s61, 49152
    s_cmp_eq_u32 s63, 1
    s_cselect_b32 s61, 737280, s61
    s_cmp_eq_u32 s63, 2
    s_cselect_b32 s61, 98304, s61
    s_cmp_eq_u32 s63, 3
    s_cselect_b32 s61, 786432, s61
    buffer_load_dwordx4 v[128:131], v115, s[20:23], s61 offen
    s_add_u32 s61, s61, 8192
    buffer_load_dwordx4 v[132:135], v115, s[20:23], s61 offen
    s_mov_b32 s61, 114688
    s_cmp_eq_u32 s63, 1
    s_cselect_b32 s61, 802816, s61
    s_cmp_eq_u32 s63, 2
    s_cselect_b32 s61, 131072, s61
    s_cmp_eq_u32 s63, 3
    s_cselect_b32 s61, 819200, s61
    buffer_load_dwordx4 v[136:139], v115, s[20:23], s61 offen
    s_add_u32 s61, s61, 8192
    buffer_load_dwordx4 v[140:143], v115, s[20:23], s61 offen
    s_mov_b32 s61, 147456
    s_cmp_eq_u32 s63, 1
    s_cselect_b32 s61, 835584, s61
    s_cmp_eq_u32 s63, 2
    s_cselect_b32 s61, 196608, s61
    s_cmp_eq_u32 s63, 3
    s_cselect_b32 s61, 884736, s61
    buffer_load_dwordx4 v[144:147], v115, s[20:23], s61 offen
    s_add_u32 s61, s61, 8192
    buffer_load_dwordx4 v[148:151], v115, s[20:23], s61 offen
    ds_read_b32 v10, v16 offset:2868
    s_waitcnt lgkmcnt(0)
    v_cmp_gt_u32 vcc, 4, v10
    s_cbranch_vccnz L_lwx_20
L_lw_19:
    ds_read_b64_tr_b16 v[20:21], v3 offset:3072
    ds_read_b64_tr_b16 v[22:23], v3 offset:4608
    ds_read_b64_tr_b16 v[24:25], v3 offset:6144
    ds_read_b64_tr_b16 v[26:27], v3 offset:7680
    ds_read_b64_tr_b16 v[28:29], v3 offset:9216
    ds_read_b64_tr_b16 v[30:31], v3 offset:10752
    ds_read_b64_tr_b16 v[32:33], v3 offset:12288
    ds_read_b64_tr_b16 v[34:35], v3 offset:13824
    ds_read_b64_tr_b16 v[36:37], v3 offset:15360
    ds_read_b64_tr_b16 v[38:39], v3 offset:16896
    ds_read_b64_tr_b16 v[40:41], v3 offset:18432
    ds_read_b64_tr_b16 v[42:43], v3 offset:19968
    ds_read_b64_tr_b16 v[44:45], v3 offset:21504
    ds_read_b64_tr_b16 v[46:47], v3 offset:23040
    ds_read_b64_tr_b16 v[48:49], v3 offset:24576
    s_waitcnt lgkmcnt(14)
    ds_read_b64_tr_b16 v[50:51], v3 offset:26112
    s_waitcnt lgkmcnt(8)
    v_dot2c_f32_bf16 v100, v20, v18
    v_dot2c_f32_bf16 v101, v21, v18
    v_dot2c_f32_bf16 v100, v22, v18
    v_dot2c_f32_bf16 v101, v23, v18
    v_dot2c_f32_bf16 v100, v24, v18
    v_dot2c_f32_bf16 v101, v25, v18
    v_dot2c_f32_bf16 v100, v26, v18
    v_dot2c_f32_bf16 v101, v27, v18
    v_dot2c_f32_bf16 v100, v28, v18
    v_dot2c_f32_bf16 v101, v29, v18
    v_dot2c_f32_bf16 v100, v30, v18
    v_dot2c_f32_bf16 v101, v31, v18
    v_dot2c_f32_bf16 v100, v32, v18
    v_dot2c_f32_bf16 v101, v33, v18
    v_dot2c_f32_bf16 v100, v34, v18
    v_dot2c_f32_bf16 v101, v35, v18
    ds_read_b64_tr_b16 v[20:21], v3 offset:27648
    ds_read_b64_tr_b16 v[22:23], v3 offset:29184
    ds_read_b64_tr_b16 v[24:25], v3 offset:30720
    ds_read_b64_tr_b16 v[26:27], v3 offset:32256
    ds_read_b64_tr_b16 v[28:29], v3 offset:33792
    ds_read_b64_tr_b16 v[30:31], v3 offset:35328
    ds_read_b64_tr_b16 v[32:33], v3 offset:36864
    s_waitcnt lgkmcnt(14)
    ds_read_b64_tr_b16 v[34:35], v3 offset:38400
    s_waitcnt lgkmcnt(8)
    v_dot2c_f32_bf16 v100, v36, v18
    v_dot2c_f32_bf16 v101, v37, v18
    v_dot2c_f32_bf16 v100, v38, v18
    v_dot2c_f32_bf16 v101, v39, v18
    v_dot2c_f32_bf16 v100, v40, v18
    v_dot2c_f32_bf16 v101, v41, v18
    v_dot2c_f32_bf16 v100, v42, v18
    v_dot2c_f32_bf16 v101, v43, v18
    v_dot2c_f32_bf16 v100, v44, v18
    v_dot2c_f32_bf16 v101, v45, v18
    v_dot2c_f32_bf16 v100, v46, v18
    v_dot2c_f32_bf16 v101, v47, v18
    v_dot2c_f32_bf16 v100, v48, v18
    v_dot2c_f32_bf16 v101, v49, v18
    v_dot2c_f32_bf16 v100, v50, v18
    v_dot2c_f32_bf16 v101, v51, v18
    ds_read_b64_tr_b16 v[36:37], v3 offset:39936
    ds_read_b64_tr_b16 v[38:39], v3 offset:41472
    ds_read_b64_tr_b16 v[40:41], v3 offset:43008
    ds_read_b64_tr_b16 v[42:43], v3 offset:44544
    ds_read_b64_tr_b16 v[44:45], v3 offset:46080
    ds_read_b64_tr_b16 v[46:47], v3 offset:47616
    ds_read_b64_tr_b16 v[48:49], v3 offset:49152
    s_waitcnt lgkmcnt(14)
    ds_read_b64_tr_b16 v[50:51], v3 offset:50688
    s_waitcnt lgkmcnt(8)
    v_dot2c_f32_bf16 v100, v20, v18
    v_dot2c_f32_bf16 v101, v21, v18
    v_dot2c_f32_bf16 v100, v22, v18
    v_dot2c_f32_bf16 v101, v23, v18
    v_dot2c_f32_bf16 v100, v24, v18
    v_dot2c_f32_bf16 v101, v25, v18
    v_dot2c_f32_bf16 v100, v26, v18
    v_dot2c_f32_bf16 v101, v27, v18
    v_dot2c_f32_bf16 v100, v28, v18
    v_dot2c_f32_bf16 v101, v29, v18
    v_dot2c_f32_bf16 v100, v30, v18
    v_dot2c_f32_bf16 v101, v31, v18
    v_dot2c_f32_bf16 v100, v32, v18
    v_dot2c_f32_bf16 v101, v33, v18
    v_dot2c_f32_bf16 v100, v34, v18
    v_dot2c_f32_bf16 v101, v35, v18
    ds_read_b64_tr_b16 v[20:21], v3 offset:52224
    ds_read_b64_tr_b16 v[22:23], v3 offset:53760
    ds_read_b64_tr_b16 v[24:25], v3 offset:55296
    ds_read_b64_tr_b16 v[26:27], v3 offset:56832
    ds_read_b64_tr_b16 v[28:29], v3 offset:58368
    ds_read_b64_tr_b16 v[30:31], v3 offset:59904
    ds_read_b64_tr_b16 v[32:33], v3 offset:61440
    s_waitcnt lgkmcnt(14)
    ds_read_b64_tr_b16 v[34:35], v3 offset:62976
    s_waitcnt lgkmcnt(8)
    v_dot2c_f32_bf16 v100, v36, v18
    v_dot2c_f32_bf16 v101, v37, v18
    v_dot2c_f32_bf16 v100, v38, v18
    v_dot2c_f32_bf16 v101, v39, v18
    v_dot2c_f32_bf16 v100, v40, v18
    v_dot2c_f32_bf16 v101, v41, v18
    v_dot2c_f32_bf16 v100, v42, v18
    v_dot2c_f32_bf16 v101, v43, v18
    v_dot2c_f32_bf16 v100, v44, v18
    v_dot2c_f32_bf16 v101, v45, v18
    v_dot2c_f32_bf16 v100, v46, v18
    v_dot2c_f32_bf16 v101, v47, v18
    v_dot2c_f32_bf16 v100, v48, v18
    v_dot2c_f32_bf16 v101, v49, v18
    v_dot2c_f32_bf16 v100, v50, v18
    v_dot2c_f32_bf16 v101, v51, v18
    ds_read_b64_tr_b16 v[36:37], v3 offset:64512
    ds_read_b64_tr_b16 v[38:39], v4 offset:512
    ds_read_b64_tr_b16 v[40:41], v4 offset:2048
    ds_read_b64_tr_b16 v[42:43], v4 offset:3584
    ds_read_b64_tr_b16 v[44:45], v4 offset:5120
    ds_read_b64_tr_b16 v[46:47], v4 offset:6656
    ds_read_b64_tr_b16 v[48:49], v4 offset:8192
    s_waitcnt lgkmcnt(14)
    ds_read_b64_tr_b16 v[50:51], v4 offset:9728
    s_waitcnt lgkmcnt(8)
    v_dot2c_f32_bf16 v100, v20, v18
    v_dot2c_f32_bf16 v101, v21, v18
    v_dot2c_f32_bf16 v100, v22, v18
    v_dot2c_f32_bf16 v101, v23, v18
    v_dot2c_f32_bf16 v100, v24, v18
    v_dot2c_f32_bf16 v101, v25, v18
    v_dot2c_f32_bf16 v100, v26, v18
    v_dot2c_f32_bf16 v101, v27, v18
    v_dot2c_f32_bf16 v100, v28, v18
    v_dot2c_f32_bf16 v101, v29, v18
    v_dot2c_f32_bf16 v100, v30, v18
    v_dot2c_f32_bf16 v101, v31, v18
    v_dot2c_f32_bf16 v100, v32, v18
    v_dot2c_f32_bf16 v101, v33, v18
    v_dot2c_f32_bf16 v100, v34, v18
    v_dot2c_f32_bf16 v101, v35, v18
    ds_read_b64_tr_b16 v[20:21], v4 offset:11264
    ds_read_b64_tr_b16 v[22:23], v4 offset:12800
    ds_read_b64_tr_b16 v[24:25], v4 offset:14336
    ds_read_b64_tr_b16 v[26:27], v4 offset:15872
    ds_read_b64_tr_b16 v[28:29], v4 offset:17408
    ds_read_b64_tr_b16 v[30:31], v4 offset:18944
    ds_read_b64_tr_b16 v[32:33], v4 offset:20480
    s_waitcnt lgkmcnt(14)
    ds_read_b64_tr_b16 v[34:35], v4 offset:22016
    s_waitcnt lgkmcnt(8)
    v_dot2c_f32_bf16 v100, v36, v18
    v_dot2c_f32_bf16 v101, v37, v18
    v_dot2c_f32_bf16 v100, v38, v18
    v_dot2c_f32_bf16 v101, v39, v18
    v_dot2c_f32_bf16 v100, v40, v18
    v_dot2c_f32_bf16 v101, v41, v18
    v_dot2c_f32_bf16 v100, v42, v18
    v_dot2c_f32_bf16 v101, v43, v18
    v_dot2c_f32_bf16 v100, v44, v18
    v_dot2c_f32_bf16 v101, v45, v18
    v_dot2c_f32_bf16 v100, v46, v18
    v_dot2c_f32_bf16 v101, v47, v18
    v_dot2c_f32_bf16 v100, v48, v18
    v_dot2c_f32_bf16 v101, v49, v18
    v_dot2c_f32_bf16 v100, v50, v18
    v_dot2c_f32_bf16 v101, v51, v18
    ds_read_b64_tr_b16 v[36:37], v4 offset:23552
    ds_read_b64_tr_b16 v[38:39], v4 offset:25088
    ds_read_b64_tr_b16 v[40:41], v4 offset:26624
    ds_read_b64_tr_b16 v[42:43], v4 offset:28160
    ds_read_b64_tr_b16 v[44:45], v4 offset:29696
    ds_read_b64_tr_b16 v[46:47], v4 offset:31232
    ds_read_b64_tr_b16 v[48:49], v4 offset:32768
    s_waitcnt lgkmcnt(14)
    ds_read_b64_tr_b16 v[50:51], v4 offset:34304
    s_waitcnt lgkmcnt(8)
    v_dot2c_f32_bf16 v100, v20, v18
    v_dot2c_f32_bf16 v101, v21, v18
    v_dot2c_f32_bf16 v100, v22, v18
    v_dot2c_f32_bf16 v101, v23, v18
    v_dot2c_f32_bf16 v100, v24, v18
    v_dot2c_f32_bf16 v101, v25, v18
    v_dot2c_f32_bf16 v100, v26, v18
    v_dot2c_f32_bf16 v101, v27, v18
    v_dot2c_f32_bf16 v100, v28, v18
    v_dot2c_f32_bf16 v101, v29, v18
    v_dot2c_f32_bf16 v100, v30, v18
    v_dot2c_f32_bf16 v101, v31, v18
    v_dot2c_f32_bf16 v100, v32, v18
    v_dot2c_f32_bf16 v101, v33, v18
    v_dot2c_f32_bf16 v100, v34, v18
    v_dot2c_f32_bf16 v101, v35, v18
    s_waitcnt lgkmcnt(0)
    v_dot2c_f32_bf16 v100, v36, v18
    v_dot2c_f32_bf16 v101, v37, v18
    v_dot2c_f32_bf16 v100, v38, v18
    v_dot2c_f32_bf16 v101, v39, v18
    v_dot2c_f32_bf16 v100, v40, v18
    v_dot2c_f32_bf16 v101, v41, v18
    v_dot2c_f32_bf16 v100, v42, v18
    v_dot2c_f32_bf16 v101, v43, v18
    v_dot2c_f32_bf16 v100, v44, v18
    v_dot2c_f32_bf16 v101, v45, v18
    v_dot2c_f32_bf16 v100, v46, v18
    v_dot2c_f32_bf16 v101, v47, v18
    v_dot2c_f32_bf16 v100, v48, v18
    v_dot2c_f32_bf16 v101, v49, v18
    v_dot2c_f32_bf16 v100, v50, v18
    v_dot2c_f32_bf16 v101, v51, v18
    s_nop 2
    v_add_f32 v100, v100, v101
    v_mov_b32 v101, v100
    s_nop 1
    v_permlane32_swap_b32 v100, v101
    v_add_f32 v100, v100, v101
    v_and_b32 v10, 31, v1
    v_lshlrev_b32 v10, 2, v10
    s_lshl_b32 s56, s56, 1
    v_add_u32 v11, s56, v10
    ds_write_b32 v11, v100 offset:1536
    s_lshl_b32 s56, s46, 2
    s_add_u32 s56, s56, s63
    s_lshl_b32 s57, s56, 7
    s_add_u32 s57, s57, 49152
    v_and_b32 v12, 15, v1
    v_lshlrev_b32 v12, 2, v12
    v_add_u32 v12, s57, v12
    s_lshl_b32 s56, s56, 12
    s_add_u32 s56, s56, 10485760
    v_lshrrev_b32 v13, 5, v1
    v_lshlrev_b32 v13, 11, v13
    v_lshl_add_u32 v13, v10, 1, v13
    s_mov_b32 s55, 0
L_poll_21:
    buffer_load_dword v11, v12, s[28:31], 0 offen sc1
    s_waitcnt vmcnt(0)
    v_cmp_ne_u32 vcc, s52, v11
    s_cbranch_vccnz L_pollx_23
L_polld_22:
    buffer_load_dwordx2 v[20:21], v13, s[28:31], s56 offen offset:0 sc1
    buffer_load_dwordx2 v[22:23], v13, s[28:31], s56 offen offset:256 sc1
    buffer_load_dwordx2 v[24:25], v13, s[28:31], s56 offen offset:512 sc1
    buffer_load_dwordx2 v[26:27], v13, s[28:31], s56 offen offset:768 sc1
    buffer_load_dwordx2 v[28:29], v13, s[28:31], s56 offen offset:1024 sc1
    buffer_load_dwordx2 v[30:31], v13, s[28:31], s56 offen offset:1280 sc1
    buffer_load_dwordx2 v[32:33], v13, s[28:31], s56 offen offset:1536 sc1
    buffer_load_dwordx2 v[34:35], v13, s[28:31], s56 offen offset:1792 sc1
    s_lshl_b32 s55, s63, 7
    v_add_u32 v10, s55, v10
    s_waitcnt vmcnt(0)
    v_add_f32 v20, v20, v22
    v_add_f32 v21, v21, v23
    v_add_f32 v20, v20, v24
    v_add_f32 v21, v21, v25
    v_add_f32 v20, v20, v26
    v_add_f32 v21, v21, v27
    v_add_f32 v20, v20, v28
    v_add_f32 v21, v21, v29
    v_add_f32 v20, v20, v30
    v_add_f32 v21, v21, v31
    v_add_f32 v20, v20, v32
    v_add_f32 v21, v21, v33
    v_add_f32 v20, v20, v34
    v_add_f32 v21, v21, v35
    v_mov_b32 v11, v20
    s_nop 1
    v_permlane32_swap_b32 v20, v11
    v_add_f32 v20, v20, v11
    v_mov_b32 v11, v21
    s_nop 1
    v_permlane32_swap_b32 v21, v11
    v_add_f32 v21, v21, v11
    v_mul_f32 v20, 0x3b000000, v20
    v_mul_f32 v21, 0x3b000000, v21
    v_fma_f32 v21, -v20, v20, v21
    v_max_f32 v21, 0, v21
    v_add_f32 v21, 0x3727c5ac, v21
    v_rsq_f32 v22, v21
    s_nop 0
    v_mul_f32 v23, v20, v22
    v_sub_f32 v23, 0, v23
    ds_write_b32 v10, v22 offset:0
    ds_write_b32 v10, v23 offset:512
    s_mov_b64 exec, 1
    ds_add_u32 v16, v17 offset:2824
    s_mov_b64 exec, -1
    s_lshl_b32 s55, s63, 11
    s_add_u32 s55, s55, 3072
    v_add_u32 v3, s55, v2
    v_add_u32 v4, 0x10000, v3
    ds_read_b32 v10, v16 offset:2816
    s_waitcnt lgkmcnt(0)
    v_cmp_gt_u32 vcc, 4, v10
    s_cbranch_vccnz L_lwx_25
L_lw_24:
    s_mov_b32 s61, 262144
    s_cmp_eq_u32 s63, 1
    s_cselect_b32 s61, 278528, s61
    s_cmp_eq_u32 s63, 2
    s_cselect_b32 s61, 360448, s61
    s_cmp_eq_u32 s63, 3
    s_cselect_b32 s61, 376832, s61
    s_mul_i32 s62, s63, 2048
    s_add_u32 s62, s62, 118784
    s_mov_b32 m0, s62
    s_nop 0
    buffer_load_dwordx4 v115, s[20:23], s61 offen lds
    s_add_u32 s61, s61, 8192
    s_add_u32 m0, s62, 1024
    s_nop 0
    buffer_load_dwordx4 v115, s[20:23], s61 offen lds
    s_mov_b32 s61, 458752
    s_cmp_eq_u32 s63, 1
    s_cselect_b32 s61, 475136, s61
    s_cmp_eq_u32 s63, 2
    s_cselect_b32 s61, 557056, s61
    s_cmp_eq_u32 s63, 3
    s_cselect_b32 s61, 573440, s61
    s_mul_i32 s62, s63, 2048
    s_add_u32 s62, s62, 126976
    s_mov_b32 m0, s62
    s_nop 0
    buffer_load_dwordx4 v115, s[20:23], s61 offen lds
    s_add_u32 s61, s61, 8192
    s_add_u32 m0, s62, 1024
    s_nop 0
    buffer_load_dwordx4 v115, s[20:23], s61 offen lds
    s_mov_b32 s61, 655360
    s_cmp_eq_u32 s63, 1
    s_cselect_b32 s61, 671744, s61
    s_cmp_eq_u32 s63, 2
    s_cselect_b32 s61, 0, s61
    s_cmp_eq_u32 s63, 3
    s_cselect_b32 s61, 950272, s61
    s_mul_i32 s62, s63, 2048
    s_add_u32 s62, s62, 135168
    s_mov_b32 m0, s62
    s_nop 0
    buffer_load_dwordx4 v115, s[20:23], s61 offen lds
    s_add_u32 s61, s61, 8192
    s_add_u32 m0, s62, 1024
    s_nop 0
    buffer_load_dwordx4 v115, s[20:23], s61 offen lds
    s_mov_b32 s61, 966656
    s_cmp_eq_u32 s63, 1
    s_cselect_b32 s61, 1048576, s61
    s_cmp_eq_u32 s63, 2
    s_cselect_b32 s61, 1064960, s61
    s_cmp_eq_u32 s63, 3
    s_cselect_b32 s61, 1146880, s61
    s_mul_i32 s62, s63, 2048
    s_add_u32 s62, s62, 143360
    s_mov_b32 m0, s62
    s_nop 0
    buffer_load_dwordx4 v115, s[20:23], s61 offen lds
    s_add_u32 s61, s61, 8192
    s_add_u32 m0, s62, 1024
    s_nop 0
    buffer_load_dwordx4 v115, s[20:23], s61 offen lds
    s_mov_b32 s61, 1163264
    s_cmp_eq_u32 s63, 1
    s_cselect_b32 s61, 1245184, s61
    s_cmp_eq_u32 s63, 2
    s_cselect_b32 s61, 1261568, s61
    s_cmp_eq_u32 s63, 3
    s_cselect_b32 s61, 1343488, s61
    s_mul_i32 s62, s63, 2048
    s_add_u32 s62, s62, 151552
    s_mov_b32 m0, s62
    s_nop 0
    buffer_load_dwordx4 v115, s[20:23], s61 offen lds
    s_add_u32 s61, s61, 8192
    s_add_u32 m0, s62, 1024
    s_nop 0
    buffer_load_dwordx4 v115, s[20:23], s61 offen lds
    s_mov_b32 s61, 1359872
    s_cmp_eq_u32 s63, 1
    s_cselect_b32 s61, 688128, s61
    s_cmp_eq_u32 s63, 2
    s_cselect_b32 s61, 688128, s61
    s_cmp_eq_u32 s63, 3
    s_cselect_b32 s61, 688128, s61
    s_mov_b32 s62, 159744
    s_cmp_eq_u32 s63, 1
    s_cselect_b32 s62, 161792, s62
    s_cmp_eq_u32 s63, 2
    s_cselect_b32 s62, 161792, s62
    s_cmp_eq_u32 s63, 3
    s_cselect_b32 s62, 161792, s62
    s_mov_b32 m0, s62
    s_nop 0
    buffer_load_dwordx4 v115, s[20:23], s61 offen lds
    s_add_u32 s61, s61, 8192
    s_add_u32 m0, s62, 1024
    s_nop 0
    buffer_load_dwordx4 v115, s[20:23], s61 offen lds
    s_mov_b32 s61, 212992
    s_cmp_eq_u32 s63, 1
    s_cselect_b32 s61, 901120, s61
    s_cmp_eq_u32 s63, 2
    s_cselect_b32 s61, 229376, s61
    s_cmp_eq_u32 s63, 3
    s_cselect_b32 s61, 917504, s61
    buffer_load_dwordx4 v[152:155], v115, s[20:23], s61 offen
    s_add_u32 s61, s61, 8192
    buffer_load_dwordx4 v[156:159], v115, s[20:23], s61 offen
    s_mov_b32 s61, 245760
    s_cmp_eq_u32 s63, 1
    s_cselect_b32 s61, 933888, s61
    s_cmp_eq_u32 s63, 2
    s_cselect_b32 s61, 294912, s61
    s_cmp_eq_u32 s63, 3
    s_cselect_b32 s61, 983040, s61
    buffer_load_dwordx4 v[160:163], v115, s[20:23], s61 offen
    s_add_u32 s61, s61, 8192
    buffer_load_dwordx4 v[164:167], v115, s[20:23], s61 offen
    s_mov_b32 s61, 311296
    s_cmp_eq_u32 s63, 1
    s_cselect_b32 s61, 999424, s61
    s_cmp_eq_u32 s63, 2
    s_cselect_b32 s61, 327680, s61
    s_cmp_eq_u32 s63, 3
    s_cselect_b32 s61, 1015808, s61
    buffer_load_dwordx4 v[168:171], v115, s[20:23], s61 offen
    s_add_u32 s61, s61, 8192
    buffer_load_dwordx4 v[172:175], v115, s[20:23], s61 offen
    s_mov_b32 s61, 344064
    s_cmp_eq_u32 s63, 1
    s_cselect_b32 s61, 1032192, s61
    s_cmp_eq_u32 s63, 2
    s_cselect_b32 s61, 393216, s61
    s_cmp_eq_u32 s63, 3
    s_cselect_b32 s61, 1081344, s61
    buffer_load_dwordx4 v[176:179], v115, s[20:23], s61 offen
    s_add_u32 s61, s61, 8192
    buffer_load_dwordx4 v[180:183], v115, s[20:23], s61 offen
    s_waitcnt vmcnt(8)
    s_mov_b64 exec, 1
    ds_add_u32 v16, v17 offset:2828
    s_mov_b64 exec, -1
    s_mov_b32 s61, 409600
    s_cmp_eq_u32 s63, 1
    s_cselect_b32 s61, 1097728, s61
    s_cmp_eq_u32 s63, 2
    s_cselect_b32 s61, 425984, s61
    s_cmp_eq_u32 s63, 3
    s_cselect_b32 s61, 1114112, s61
    buffer_load_dwordx4 v[184:187], v115, s[20:23], s61 offen
    s_add_u32 s61, s61, 8192
    buffer_load_dwordx4 v[188:191], v115, s[20:23], s61 offen
    s_mov_b32 s61, 442368
    s_cmp_eq_u32 s63, 1
    s_cselect_b32 s61, 1130496, s61
    s_cmp_eq_u32 s63, 2
    s_cselect_b32 s61, 491520, s61
    s_cmp_eq_u32 s63, 3
    s_cselect_b32 s61, 1179648, s61
    buffer_load_dwordx4 v[192:195], v115, s[20:23], s61 offen
    s_add_u32 s61, s61, 8192
    buffer_load_dwordx4 v[196:199], v115, s[20:23], s61 offen
    s_mov_b32 s61, 507904
    s_cmp_eq_u32 s63, 1
    s_cselect_b32 s61, 1196032, s61
    s_cmp_eq_u32 s63, 2
    s_cselect_b32 s61, 524288, s61
    s_cmp_eq_u32 s63, 3
    s_cselect_b32 s61, 1212416, s61
    buffer_load_dwordx4 v[200:203], v115, s[20:23], s61 offen
    s_add_u32 s61, s61, 8192
    buffer_load_dwordx4 v[204:207], v115, s[20:23], s61 offen
    s_mov_b32 s61, 540672
    s_cmp_eq_u32 s63, 1
    s_cselect_b32 s61, 1228800, s61
    s_cmp_eq_u32 s63, 2
    s_cselect_b32 s61, 589824, s61
    s_cmp_eq_u32 s63, 3
    s_cselect_b32 s61, 1277952, s61
    buffer_load_dwordx4 v[208:211], v115, s[20:23], s61 offen
    s_add_u32 s61, s61, 8192
    buffer_load_dwordx4 v[212:215], v115, s[20:23], s61 offen
    s_mov_b32 s61, 606208
    s_cmp_eq_u32 s63, 1
    s_cselect_b32 s61, 1294336, s61
    s_cmp_eq_u32 s63, 2
    s_cselect_b32 s61, 622592, s61
    s_cmp_eq_u32 s63, 3
    s_cselect_b32 s61, 1310720, s61
    buffer_load_dwordx4 v[216:219], v115, s[20:23], s61 offen
    s_add_u32 s61, s61, 8192
    buffer_load_dwordx4 v[220:223], v115, s[20:23], s61 offen
    s_mov_b32 s61, 638976
    s_cmp_eq_u32 s63, 1
    s_cselect_b32 s61, 1327104, s61
    s_cmp_eq_u32 s63, 2
    s_cselect_b32 s61, 1376256, s61
    s_cmp_eq_u32 s63, 3
    s_cselect_b32 s61, 1392640, s61
    buffer_load_dwordx4 v[224:227], v115, s[20:23], s61 offen
    s_add_u32 s61, s61, 8192
    buffer_load_dwordx4 v[228:231], v115, s[20:23], s61 offen
    ds_read_b32 v10, v16 offset:2820
    s_waitcnt lgkmcnt(0)
    v_cmp_gt_u32 vcc, 4, v10
    s_cbranch_vccnz L_lwx_27
L_lw_26:
    ds_write_b128 v3, v[120:123] offset:0
    ds_write_b128 v3, v[124:127] offset:1024
    ds_write_b128 v3, v[128:131] offset:8192
    ds_write_b128 v3, v[132:135] offset:9216
    s_waitcnt lgkmcnt(4)
    ds_write_b128 v3, v[136:139] offset:16384
    ds_write_b128 v3, v[140:143] offset:17408
    ds_write_b128 v3, v[144:147] offset:24576
    ds_write_b128 v3, v[148:151] offset:25600
    s_waitcnt lgkmcnt(4)
    s_waitcnt vmcnt(19)
    ds_write_b128 v3, v[152:155] offset:32768
    s_waitcnt vmcnt(18)
    ds_write_b128 v3, v[156:159] offset:33792
    s_waitcnt vmcnt(17)
    ds_write_b128 v3, v[160:163] offset:40960
    s_waitcnt vmcnt(16)
    ds_write_b128 v3, v[164:167] offset:41984
    s_waitcnt lgkmcnt(4)
    s_waitcnt vmcnt(15)
    ds_write_b128 v3, v[168:171] offset:49152
    s_waitcnt vmcnt(14)
    ds_write_b128 v3, v[172:175] offset:50176
    s_waitcnt vmcnt(13)
    ds_write_b128 v3, v[176:179] offset:57344
    s_waitcnt vmcnt(12)
    ds_write_b128 v3, v[180:183] offset:58368
    s_waitcnt lgkmcnt(4)
    s_waitcnt vmcnt(11)
    ds_write_b128 v4, v[184:187] offset:0
    s_waitcnt vmcnt(10)
    ds_write_b128 v4, v[188:191] offset:1024
    s_waitcnt vmcnt(9)
    ds_write_b128 v4, v[192:195] offset:8192
    s_waitcnt vmcnt(8)
    ds_write_b128 v4, v[196:199] offset:9216
    s_waitcnt lgkmcnt(4)
    s_waitcnt vmcnt(7)
    ds_write_b128 v4, v[200:203] offset:16384
    s_waitcnt vmcnt(6)
    ds_write_b128 v4, v[204:207] offset:17408
    s_waitcnt vmcnt(5)
    ds_write_b128 v4, v[208:211] offset:24576
    s_waitcnt vmcnt(4)
    ds_write_b128 v4, v[212:215] offset:25600
    s_waitcnt lgkmcnt(4)
    s_waitcnt vmcnt(3)
    ds_write_b128 v4, v[216:219] offset:32768
    s_waitcnt vmcnt(2)
    ds_write_b128 v4, v[220:223] offset:33792
    s_waitcnt vmcnt(1)
    ds_write_b128 v4, v[224:227] offset:40960
    s_waitcnt vmcnt(0)
    ds_write_b128 v4, v[228:231] offset:41984
    s_waitcnt lgkmcnt(4)
    s_mov_b64 exec, 1
    ds_add_u32 v16, v17 offset:2832
    s_mov_b64 exec, -1
    s_cmp_lg_u32 s2, 0
    s_cbranch_scc1 L_n7_28
    s_cmp_lg_u32 s50, 7
    s_cbranch_scc1 L_n7_28
    v_lshrrev_b32 v12, 2, v1
    v_lshlrev_b32 v12, 7, v12
    v_and_b32 v13, 3, v1
    v_lshl_add_u32 v12, v13, 4, v12
    s_mov_b32 s55, 0
L_ep_29:
    s_mov_b32 s56, 65536
    buffer_load_dword v20, v12, s[28:31], s56 offen offset:4 sc1
    s_mov_b32 s56, 67584
    buffer_load_dword v21, v12, s[28:31], s56 offen offset:4 sc1
    s_mov_b32 s56, 69632
    buffer_load_dword v22, v12, s[28:31], s56 offen offset:4 sc1
    s_mov_b32 s56, 71680
    buffer_load_dword v23, v12, s[28:31], s56 offen offset:4 sc1
    s_mov_b32 s56, 73728
    buffer_load_dword v24, v12, s[28:31], s56 offen offset:4 sc1
    s_mov_b32 s56, 75776
    buffer_load_dword v25, v12, s[28:31], s56 offen offset:4 sc1
    s_mov_b32 s56, 77824
    buffer_load_dword v26, v12, s[28:31], s56 offen offset:4 sc1
    s_mov_b32 s56, 79872
    buffer_load_dword v27, v12, s[28:31], s56 offen offset:4 sc1
    s_mov_b32 s56, 81920
    buffer_load_dword v28, v12, s[28:31], s56 offen offset:4 sc1
    s_mov_b32 s56, 83968
    buffer_load_dword v29, v12, s[28:31], s56 offen offset:4 sc1
    s_mov_b32 s56, 86016
    buffer_load_dword v30, v12, s[28:31], s56 offen offset:4 sc1
    s_mov_b32 s56, 88064
    buffer_load_dword v31, v12, s[28:31], s56 offen offset:4 sc1
    s_mov_b32 s56, 90112
    buffer_load_dword v32, v12, s[28:31], s56 offen offset:4 sc1
    s_mov_b32 s56, 92160
    buffer_load_dword v33, v12, s[28:31], s56 offen offset:4 sc1
    s_mov_b32 s56, 94208
    buffer_load_dword v34, v12, s[28:31], s56 offen offset:4 sc1
    s_mov_b32 s56, 96256
    buffer_load_dword v35, v12, s[28:31], s56 offen offset:4 sc1
    s_waitcnt vmcnt(0)
    s_mov_b64 vcc, 0
    v_cmp_ne_u32 s[90:91], s52, v20
    s_or_b64 vcc, vcc, s[90:91]
    v_cmp_ne_u32 s[90:91], s52, v21
    s_or_b64 vcc, vcc, s[90:91]
    v_cmp_ne_u32 s[90:91], s52, v22
    s_or_b64 vcc, vcc, s[90:91]
    v_cmp_ne_u32 s[90:91], s52, v23
    s_or_b64 vcc, vcc, s[90:91]
    v_cmp_ne_u32 s[90:91], s52, v24
    s_or_b64 vcc, vcc, s[90:91]
    v_cmp_ne_u32 s[90:91], s52, v25
    s_or_b64 vcc, vcc, s[90:91]
    v_cmp_ne_u32 s[90:91], s52, v26
    s_or_b64 vcc, vcc, s[90:91]
    v_cmp_ne_u32 s[90:91], s52, v27
    s_or_b64 vcc, vcc, s[90:91]
    v_cmp_ne_u32 s[90:91], s52, v28
    s_or_b64 vcc, vcc, s[90:91]
    v_cmp_ne_u32 s[90:91], s52, v29
    s_or_b64 vcc, vcc, s[90:91]
    v_cmp_ne_u32 s[90:91], s52, v30
    s_or_b64 vcc, vcc, s[90:91]
    v_cmp_ne_u32 s[90:91], s52, v31
    s_or_b64 vcc, vcc, s[90:91]
    v_cmp_ne_u32 s[90:91], s52, v32
    s_or_b64 vcc, vcc, s[90:91]
    v_cmp_ne_u32 s[90:91], s52, v33
    s_or_b64 vcc, vcc, s[90:91]
    v_cmp_ne_u32 s[90:91], s52, v34
    s_or_b64 vcc, vcc, s[90:91]
    v_cmp_ne_u32 s[90:91], s52, v35
    s_or_b64 vcc, vcc, s[90:91]
    s_cbranch_vccz L_epd_30
    s_add_u32 s55, s55, 1
    s_cmp_lt_u32 s55, 200000
    s_cbranch_scc1 L_ep_29
L_epd_30:
    v_mov_b32 v10, 0
    v_mov_b32 v11, s52
    s_mov_b64 exec, 1
    buffer_store_dword v11, v10, s[28:31], 0 offen sc1
    s_mov_b64 exec, -1
L_n7_28:
L_end:
    s_endpgm
L_lwx_2:
    s_mov_b32 s55, 0
L_lwy_31:
    s_sleep 2
    ds_read_b32 v12, v118 offset:2844
    s_waitcnt lgkmcnt(0)
    v_cmp_gt_u32 vcc, 4, v12
    s_cbranch_vccz L_lw_1
    s_add_u32 s55, s55, 1
    s_cmp_lt_u32 s55, 1600000
    s_cbranch_scc1 L_lwy_31
    s_branch L_lw_1
L_lwx_4:
    s_mov_b32 s55, 0
L_lwy_32:
    s_sleep 2
    ds_read_b32 v13, v118 offset:2848
    s_waitcnt lgkmcnt(0)
    v_cmp_gt_u32 vcc, 4, v13
    s_cbranch_vccz L_lw_3
    s_add_u32 s55, s55, 1
    s_cmp_lt_u32 s55, 1600000
    s_cbranch_scc1 L_lwy_32
    s_branch L_lw_3
L_lwx_6:
    s_mov_b32 s55, 0
L_lwy_33:
    s_sleep 2
    ds_read_b32 v12, v118 offset:2856
    s_waitcnt lgkmcnt(0)
    v_cmp_gt_u32 vcc, 4, v12
    s_cbranch_vccz L_lw_5
    s_add_u32 s55, s55, 1
    s_cmp_lt_u32 s55, 1600000
    s_cbranch_scc1 L_lwy_33
    s_branch L_lw_5
L_fb_9:
    s_lshl_b32 s55, s46, 2
    s_add_u32 s55, s55, s51
    s_sub_i32 s55, 8, s55
    s_max_i32 s89, s55, 0
    v_mov_b32 v14, 0xf149f2ca
    s_mov_b32 s90, s89
L_fbl_34:
    s_lshl_b32 s55, s90, 11
    v_add_u32 v10, s55, v100
    s_mul_i32 s55, s90, 2080
    v_add_u32 v11, s55, v101
    ds_read_b128 v[60:63], v10
    ds_read_b128 v[68:71], v11
    ds_read_b128 v[72:75], v11 offset:1040
    s_waitcnt lgkmcnt(0)
    s_cmp_eq_u32 s90, 8
    s_cbranch_scc1 L_fbm_35
    s_cmp_eq_u32 s90, 0
    s_cbranch_scc1 L_fbn_36
    v_mfma_f32_32x32x16_bf16 v[20:35], v[60:63], v[160:163], 0
    s_branch L_fbc_37
L_fbm_35:
    v_mfma_f32_32x32x16_bf16 v[20:35], v[60:63], v[160:163], v[164:179]
    s_branch L_fbc_37
L_fbn_36:
    v_mfma_f32_32x32x16_bf16 v[20:35], v[60:63], v[160:163], v[180:195]
L_fbc_37:
    s_nop 11
    v_max_f32 v14, v14, v20
    v_max_f32 v14, v14, v21
    v_max_f32 v14, v14, v22
    v_max_f32 v14, v14, v23
    v_max_f32 v14, v14, v24
    v_max_f32 v14, v14, v25
    v_max_f32 v14, v14, v26
    v_max_f32 v14, v14, v27
    v_max_f32 v14, v14, v28
    v_max_f32 v14, v14, v29
    v_max_f32 v14, v14, v30
    v_max_f32 v14, v14, v31
    v_max_f32 v14, v14, v32
    v_max_f32 v14, v14, v33
    v_max_f32 v14, v14, v34
    v_max_f32 v14, v14, v35
    s_add_u32 s90, s90, 1
    s_cmp_le_u32 s90, 8
    s_cbranch_scc1 L_fbl_34
    v_mov_b32 v15, v14
    s_nop 1
    v_permlane32_swap_b32 v14, v15
    v_max_f32 v14, v14, v15
    s_mov_b32 s90, s89
    v_mov_b32 v84, 0
    v_mov_b32 v85, 0
    v_mov_b32 v86, 0
    v_mov_b32 v87, 0
    v_mov_b32 v88, 0
    v_mov_b32 v89, 0
    v_mov_b32 v90, 0
    v_mov_b32 v91, 0
    v_mov_b32 v92, 0
    v_mov_b32 v93, 0
    v_mov_b32 v94, 0
    v_mov_b32 v95, 0
    v_mov_b32 v96, 0
    v_mov_b32 v97, 0
    v_mov_b32 v98, 0
    v_mov_b32 v99, 0
L_fbl_38:
    s_lshl_b32 s55, s90, 11
    v_add_u32 v10, s55, v100
    s_mul_i32 s55, s90, 2080
    v_add_u32 v11, s55, v101
    ds_read_b128 v[60:63], v10
    ds_read_b128 v[68:71], v11
    ds_read_b128 v[72:75], v11 offset:1040
    s_waitcnt lgkmcnt(0)
    s_cmp_eq_u32 s90, 8
    s_cbranch_scc1 L_fbm_39
    s_cmp_eq_u32 s90, 0
    s_cbranch_scc1 L_fbn_40
    v_mfma_f32_32x32x16_bf16 v[20:35], v[60:63], v[160:163], 0
    s_branch L_fbc_41
L_fbm_39:
    v_mfma_f32_32x32x16_bf16 v[20:35], v[60:63], v[160:163], v[164:179]
    s_branch L_fbc_41
L_fbn_40:
    v_mfma_f32_32x32x16_bf16 v[20:35], v[60:63], v[160:163], v[180:195]
L_fbc_41:
    s_nop 11
    v_sub_f32 v20, v20, v14
    v_exp_f32 v20, v20
    v_sub_f32 v21, v21, v14
    v_exp_f32 v21, v21
    v_sub_f32 v22, v22, v14
    v_exp_f32 v22, v22
    v_sub_f32 v23, v23, v14
    v_exp_f32 v23, v23
    v_sub_f32 v24, v24, v14
    v_exp_f32 v24, v24
    v_sub_f32 v25, v25, v14
    v_exp_f32 v25, v25
    v_sub_f32 v26, v26, v14
    v_exp_f32 v26, v26
    v_sub_f32 v27, v27, v14
    v_exp_f32 v27, v27
    v_sub_f32 v28, v28, v14
    v_exp_f32 v28, v28
    v_sub_f32 v29, v29, v14
    v_exp_f32 v29, v29
    v_sub_f32 v30, v30, v14
    v_exp_f32 v30, v30
    v_sub_f32 v31, v31, v14
    v_exp_f32 v31, v31
    v_sub_f32 v32, v32, v14
    v_exp_f32 v32, v32
    v_sub_f32 v33, v33, v14
    v_exp_f32 v33, v33
    v_sub_f32 v34, v34, v14
    v_exp_f32 v34, v34
    v_sub_f32 v35, v35, v14
    v_exp_f32 v35, v35
    v_cvt_pk_bf16_f32 v52, v20, v21
    v_cvt_pk_bf16_f32 v53, v22, v23
    v_cvt_pk_bf16_f32 v54, v24, v25
    v_cvt_pk_bf16_f32 v55, v26, v27
    v_cvt_pk_bf16_f32 v56, v28, v29
    v_cvt_pk_bf16_f32 v57, v30, v31
    v_cvt_pk_bf16_f32 v58, v32, v33
    v_cvt_pk_bf16_f32 v59, v34, v35
    v_mfma_f32_32x32x16_bf16 v[84:99], v[68:71], v[52:55], v[84:99]
    s_nop 0
    v_mfma_f32_32x32x16_bf16 v[84:99], v[72:75], v[56:59], v[84:99]
    s_add_u32 s90, s90, 1
    s_cmp_le_u32 s90, 8
    s_cbranch_scc1 L_fbl_38
    s_branch L_fbret_10
L_rdx_12:
    s_mov_b32 s55, 0
L_poll_42:
    buffer_load_dword v103, v102, s[28:31], 0 offen sc1
    s_waitcnt vmcnt(0)
    v_cmp_ne_u32 vcc, s52, v103
    s_cbranch_vccnz L_pollx_44
L_polld_43:
    s_branch L_rdc_11
L_safe_13:
    buffer_store_dwordx4 v[12:15], v2, s[28:31], s61 offen sc1
    s_branch L_back_14
L_safe_15:
    buffer_store_dword v11, v10, s[28:31], 0 offen sc1
    s_branch L_back_16
L_lwx_18:
    s_mov_b32 s55, 0
L_lwy_45:
    s_sleep 2
    ds_read_b32 v10, v16 offset:2840
    s_waitcnt lgkmcnt(0)
    v_cmp_gt_u32 vcc, 4, v10
    s_cbranch_vccz L_lw_17
    s_add_u32 s55, s55, 1
    s_cmp_lt_u32 s55, 1600000
    s_cbranch_scc1 L_lwy_45
    s_branch L_lw_17
L_lwx_20:
    s_mov_b32 s55, 0
L_lwy_46:
    s_sleep 2
    ds_read_b32 v10, v16 offset:2868
    s_waitcnt lgkmcnt(0)
    v_cmp_gt_u32 vcc, 4, v10
    s_cbranch_vccz L_lw_19
    s_add_u32 s55, s55, 1
    s_cmp_lt_u32 s55, 1600000
    s_cbranch_scc1 L_lwy_46
    s_branch L_lw_19
L_pollx_23:
    s_sleep 4
    s_add_u32 s55, s55, 1
    s_cmp_lt_u32 s55, 200000
    s_cbranch_scc1 L_poll_21
    s_branch L_polld_22
L_lwx_25:
    s_mov_b32 s55, 0
L_lwy_47:
    s_sleep 2
    ds_read_b32 v10, v16 offset:2816
    s_waitcnt lgkmcnt(0)
    v_cmp_gt_u32 vcc, 4, v10
    s_cbranch_vccz L_lw_24
    s_add_u32 s55, s55, 1
    s_cmp_lt_u32 s55, 1600000
    s_cbranch_scc1 L_lwy_47
    s_branch L_lw_24
L_lwx_27:
    s_mov_b32 s55, 0
L_lwy_48:
    s_sleep 2
    ds_read_b32 v10, v16 offset:2820
    s_waitcnt lgkmcnt(0)
    v_cmp_gt_u32 vcc, 4, v10
    s_cbranch_vccz L_lw_26
    s_add_u32 s55, s55, 1
    s_cmp_lt_u32 s55, 1600000
    s_cbranch_scc1 L_lwy_48
    s_branch L_lw_26
L_pollx_44:
    s_add_u32 s55, s55, 1
    s_cmp_lt_u32 s55, 200000
    s_cbranch_scc1 L_poll_42
    s_branch L_polld_43
L_CW:
    s_mov_b32 s12, s68
    s_and_b32 s13, s69, 0xffff
    s_mov_b32 s14, 524288
    s_mov_b32 s15, 0x20000
    s_mov_b32 s16, s72
    s_and_b32 s17, s73, 0xffff
    s_mov_b32 s18, 1409024
    s_mov_b32 s19, 0x20000
    s_mov_b32 s20, s76
    s_and_b32 s21, s77, 0xffff
    s_mov_b32 s22, 1409024
    s_mov_b32 s23, 0x20000
    s_mov_b32 s28, s84
    s_and_b32 s29, s85, 0xffff
    s_mov_b32 s30, 11534336
    s_mov_b32 s31, 0x20000
    s_mov_b32 s32, s74
    s_and_b32 s33, s75, 0xffff
    s_mov_b32 s34, 2752
    s_mov_b32 s35, 0x20000
    s_mov_b32 s36, s78
    s_and_b32 s37, s79, 0xffff
    s_mov_b32 s38, 1024
    s_mov_b32 s39, 0x20000
    s_mov_b32 s24, s80
    s_and_b32 s25, s81, 0xffff
    s_mov_b32 s26, 2097152
    s_mov_b32 s27, 0x20000
    s_lshr_b32 s55, s45, 3
    s_lshl_b32 s48, s44, 2
    s_add_u32 s48, s48, s55
    s_and_b32 s49, s45, 7
    s_lshr_b32 s54, s50, 2
    s_lshl_b32 s88, s46, 4
    s_add_u32 s88, s88, s47
    s_lshl_b32 s88, s88, 14
    s_add_u32 s88, s88, 1048576
    s_mov_b32 s51, s50
    s_and_b32 s94, s50, 1
    s_lshr_b32 s95, s50, 1
    v_mov_b32 v18, 0x3f803f80
    s_waitcnt lgkmcnt(0)
    s_add_u32 s52, s52, 1
    v_mov_b32 v10, 2560
    v_mov_b32 v11, s52
    ds_write_b32 v10, v11
    s_mov_b32 s65, s60
    v_and_b32 v10, 31, v1
    v_lshrrev_b32 v11, 5, v1
    v_lshlrev_b32 v11, 2, v11
    v_sub_u32 v10, v10, v11
    v_mov_b32 v12, 0xf149f2ca
    v_mov_b32 v13, 0
    v_cmp_le_i32 s[56:57], 0, v10
    v_cmp_le_i32 s[58:59], 1, v10
    v_cmp_le_i32 s[60:61], 2, v10
    v_cmp_le_i32 s[62:63], 3, v10
    v_cndmask_b32 v164, v12, v13, s[56:57]
    v_cndmask_b32 v180, v13, v12, s[56:57]
    v_cndmask_b32 v165, v12, v13, s[58:59]
    v_cndmask_b32 v181, v13, v12, s[58:59]
    v_cndmask_b32 v166, v12, v13, s[60:61]
    v_cndmask_b32 v182, v13, v12, s[60:61]
    v_cndmask_b32 v167, v12, v13, s[62:63]
    v_cndmask_b32 v183, v13, v12, s[62:63]
    v_cmp_le_i32 s[56:57], 8, v10
    v_cmp_le_i32 s[58:59], 9, v10
    v_cmp_le_i32 s[60:61], 10, v10
    v_cmp_le_i32 s[62:63], 11, v10
    v_cndmask_b32 v168, v12, v13, s[56:57]
    v_cndmask_b32 v184, v13, v12, s[56:57]
    v_cndmask_b32 v169, v12, v13, s[58:59]
    v_cndmask_b32 v185, v13, v12, s[58:59]
    v_cndmask_b32 v170, v12, v13, s[60:61]
    v_cndmask_b32 v186, v13, v12, s[60:61]
    v_cndmask_b32 v171, v12, v13, s[62:63]
    v_cndmask_b32 v187, v13, v12, s[62:63]
    v_cmp_le_i32 s[56:57], 16, v10
    v_cmp_le_i32 s[58:59], 17, v10
    v_cmp_le_i32 s[60:61], 18, v10
    v_cmp_le_i32 s[62:63], 19, v10
    v_cndmask_b32 v172, v12, v13, s[56:57]
    v_cndmask_b32 v188, v13, v12, s[56:57]
    v_cndmask_b32 v173, v12, v13, s[58:59]
    v_cndmask_b32 v189, v13, v12, s[58:59]
    v_cndmask_b32 v174, v12, v13, s[60:61]
    v_cndmask_b32 v190, v13, v12, s[60:61]
    v_cndmask_b32 v175, v12, v13, s[62:63]
    v_cndmask_b32 v191, v13, v12, s[62:63]
    v_cmp_le_i32 s[56:57], 24, v10
    v_cmp_le_i32 s[58:59], 25, v10
    v_cmp_le_i32 s[60:61], 26, v10
    v_cmp_le_i32 s[62:63], 27, v10
    v_cndmask_b32 v176, v12, v13, s[56:57]
    v_cndmask_b32 v192, v13, v12, s[56:57]
    v_cndmask_b32 v177, v12, v13, s[58:59]
    v_cndmask_b32 v193, v13, v12, s[58:59]
    v_cndmask_b32 v178, v12, v13, s[60:61]
    v_cndmask_b32 v194, v13, v12, s[60:61]
    v_cndmask_b32 v179, v12, v13, s[62:63]
    v_cndmask_b32 v195, v13, v12, s[62:63]
    s_and_b32 s63, s50, 3
    v_and_b32 v10, 31, v1
    s_lshl_b32 s55, s51, 5
    v_add_u32 v10, s55, v10
    v_bfe_u32 v11, v10, 1, 3
    v_lshrrev_b32 v12, 5, v1
    v_xor_b32 v11, v11, v12
    v_lshlrev_b32 v11, 4, v11
    v_lshl_add_u32 v9, v10, 7, v11
    s_lshl_b32 s55, s46, 11
    s_add_u32 s55, s55, 65536
    v_lshlrev_b32 v8, 4, v10
    v_add_u32 v8, s55, v8
    v_and_b32 v7, 31, v1
    v_lshlrev_b32 v7, 3, v7
    s_lshl_b32 s56, s44, 8
    s_add_u32 s56, s56, 4096
    v_add_u32 v7, s56, v7
    v_bfe_u32 v10, v1, 2, 2
    v_lshrrev_b32 v11, 5, v1
    v_lshl_add_u32 v10, v11, 3, v10
    v_lshlrev_b32 v10, 7, v10
    v_bfe_u32 v11, v1, 4, 1
    v_lshl_add_u32 v10, v11, 5, v10
    v_and_b32 v11, 3, v1
    v_lshl_add_u32 v10, v11, 3, v10
    v_bfe_u32 v11, v1, 3, 1
    v_lshl_add_u32 v19, v11, 6, v10
    s_lshl_b32 s57, s46, 4
    s_add_u32 s57, s57, s47
    s_lshl_b32 s59, s57, 5
    s_add_u32 s59, s59, s50
    s_lshl_b32 s59, s59, 2
    s_add_u32 s59, s59, 8192
    s_lshl_b32 s60, s50, 12
    s_add_u32 s60, s60, s88
    s_add_u32 s57, s60, 524288
    s_cmp_ge_u32 s46, 1
    s_cselect_b32 s55, 2048, 0
    s_sub_u32 s55, s59, s55
    s_cmp_ge_u32 s46, 2
    s_cselect_b32 s56, 4096, 0
    s_sub_u32 s56, s59, s56
    v_mov_b32 v6, s55
    v_mov_b32 v11, s56
    v_and_b32 v12, 1, v1
    v_cmp_eq_u32 vcc, 1, v12
    s_nop 1
    v_cndmask_b32 v6, v6, v11, vcc
    s_lshl_b32 s65, s65, 4
    s_add_u32 s65, s65, 65536
    v_mov_b32 v3, s65
    v_mov_b32 v200, 0
    v_mov_b32 v202, 0
    v_mov_b32 v212, 0
    v_mov_b32 v214, 0
    s_getreg_b32 s56, hwreg(HW_REG_XCC_ID)
    s_and_b32 s56, s56, 15
    v_mov_b32 v221, s56
    v_mov_b32 v220, s52
    s_lshl_b32 s56, s44, 5
    s_add_u32 s56, s56, s45
    s_lshl_b32 s56, s56, 3
    s_add_u32 s56, s56, 4096
    s_cmp_eq_u32 s50, 0
    s_cselect_b32 s56, s56, 2146435072
    v_mov_b32 v222, s56
    s_waitcnt vmcnt(0)
    v_dot2c_f32_bf16 v200, v196, v18
    v_dot2c_f32_bf16 v202, v196, v196
    v_dot2c_f32_bf16 v212, v208, v18
    v_dot2c_f32_bf16 v214, v208, v208
    v_dot2c_f32_bf16 v200, v197, v18
    v_dot2c_f32_bf16 v202, v197, v197
    v_dot2c_f32_bf16 v212, v209, v18
    v_dot2c_f32_bf16 v214, v209, v209
    v_dot2c_f32_bf16 v200, v198, v18
    v_dot2c_f32_bf16 v202, v198, v198
    v_dot2c_f32_bf16 v212, v210, v18
    v_dot2c_f32_bf16 v214, v210, v210
    v_dot2c_f32_bf16 v200, v199, v18
    v_dot2c_f32_bf16 v202, v199, v199
    v_dot2c_f32_bf16 v212, v211, v18
    v_dot2c_f32_bf16 v214, v211, v211
    v_add_f32_dpp v200, v200, v200 row_ror:8 row_mask:0xf bank_mask:0xf
    v_add_f32_dpp v202, v202, v202 row_ror:8 row_mask:0xf bank_mask:0xf
    v_add_f32_dpp v212, v212, v212 row_ror:8 row_mask:0xf bank_mask:0xf
    v_add_f32_dpp v214, v214, v214 row_ror:8 row_mask:0xf bank_mask:0xf
    v_add_f32_dpp v200, v200, v200 row_ror:4 row_mask:0xf bank_mask:0xf
    v_add_f32_dpp v202, v202, v202 row_ror:4 row_mask:0xf bank_mask:0xf
    v_add_f32_dpp v212, v212, v212 row_ror:4 row_mask:0xf bank_mask:0xf
    v_add_f32_dpp v214, v214, v214 row_ror:4 row_mask:0xf bank_mask:0xf
    v_add_f32_dpp v200, v200, v200 row_ror:2 row_mask:0xf bank_mask:0xf
    v_add_f32_dpp v202, v202, v202 row_ror:2 row_mask:0xf bank_mask:0xf
    v_add_f32_dpp v212, v212, v212 row_ror:2 row_mask:0xf bank_mask:0xf
    v_add_f32_dpp v214, v214, v214 row_ror:2 row_mask:0xf bank_mask:0xf
    v_add_f32_dpp v200, v200, v200 row_ror:1 row_mask:0xf bank_mask:0xf
    v_add_f32_dpp v202, v202, v202 row_ror:1 row_mask:0xf bank_mask:0xf
    v_add_f32_dpp v212, v212, v212 row_ror:1 row_mask:0xf bank_mask:0xf
    v_add_f32_dpp v214, v214, v214 row_ror:1 row_mask:0xf bank_mask:0xf
    v_mov_b32 v201, v200
    v_mov_b32 v203, v202
    v_mov_b32 v213, v212
    v_mov_b32 v215, v214
    v_permlane16_swap_b32 v200, v201
    v_permlane16_swap_b32 v202, v203
    v_permlane16_swap_b32 v212, v213
    v_permlane16_swap_b32 v214, v215
    v_add_f32 v200, v200, v201
    v_add_f32 v202, v202, v203
    v_add_f32 v212, v212, v213
    v_add_f32 v214, v214, v215
    v_mov_b32 v201, v200
    v_mov_b32 v203, v202
    v_mov_b32 v213, v212
    v_mov_b32 v215, v214
    v_permlane32_swap_b32 v200, v201
    v_permlane32_swap_b32 v202, v203
    v_permlane32_swap_b32 v212, v213
    v_permlane32_swap_b32 v214, v215
    v_add_f32 v200, v200, v201
    v_add_f32 v202, v202, v203
    v_add_f32 v212, v212, v213
    v_add_f32 v214, v214, v215
    v_mul_f32 v200, 0x3b000000, v200
    v_mul_f32 v202, 0x3b000000, v202
    v_fma_f32 v202, -v200, v200, v202
    v_max_f32 v202, 0, v202
    v_add_f32 v202, 0x3727c5ac, v202
    v_rsq_f32 v204, v202
    s_nop 0
    v_mul_f32 v206, v200, v204
    v_mov_b32 v205, s52
    v_mov_b32 v207, s52
    v_mul_f32 v212, 0x3b000000, v212
    v_mul_f32 v214, 0x3b000000, v214
    v_fma_f32 v214, -v212, v212, v214
    v_max_f32 v214, 0, v214
    v_add_f32 v214, 0x3727c5ac, v214
    v_rsq_f32 v216, v214
    s_nop 0
    v_mul_f32 v218, v212, v216
    v_mov_b32 v217, s52
    v_mov_b32 v219, s52
    s_mov_b64 exec, 1
    buffer_store_dwordx4 v[204:207], v3, s[28:31], 0 offen sc1
    buffer_store_dwordx4 v[216:219], v3, s[28:31], 0 offen offset:64 sc1
    buffer_store_dwordx2 v[220:221], v222, s[28:31], 0 offen sc1
    s_mov_b64 exec, -1
    v_add_u32 v10, 3072, v9
    v_xor_b32 v11, 32, v10
    v_xor_b32 v12, 64, v10
    v_xor_b32 v13, 96, v10
    v_add_u32 v14, 19456, v19
    v_xor_b32 v15, 64, v14
    s_waitcnt lgkmcnt(0)
    s_barrier
    ds_read_b128 v[20:23], v10
    ds_read_b64_tr_b16 v[52:53], v14 offset:0
    ds_read_b64_tr_b16 v[54:55], v14 offset:512
    ds_read_b64_tr_b16 v[68:69], v15 offset:0
    ds_read_b64_tr_b16 v[70:71], v15 offset:512
    ds_read_b128 v[24:27], v11
    ds_read_b64_tr_b16 v[56:57], v14 offset:2048
    ds_read_b64_tr_b16 v[58:59], v14 offset:2560
    ds_read_b64_tr_b16 v[72:73], v15 offset:2048
    ds_read_b64_tr_b16 v[74:75], v15 offset:2560
    ds_read_b128 v[28:31], v12
    ds_read_b64_tr_b16 v[60:61], v14 offset:4096
    ds_read_b64_tr_b16 v[62:63], v14 offset:4608
    ds_read_b64_tr_b16 v[76:77], v15 offset:4096
    s_waitcnt lgkmcnt(7)
    ds_read_b64_tr_b16 v[78:79], v15 offset:4608
    ds_read_b128 v[32:35], v13
    ds_read_b64_tr_b16 v[64:65], v14 offset:6144
    ds_read_b64_tr_b16 v[66:67], v14 offset:6656
    ds_read_b64_tr_b16 v[80:81], v15 offset:6144
    ds_read_b64_tr_b16 v[82:83], v15 offset:6656
    v_add_u32 v10, 27648, v9
    v_xor_b32 v11, 32, v10
    v_xor_b32 v12, 64, v10
    v_xor_b32 v13, 96, v10
    v_add_u32 v14, 44032, v19
    v_xor_b32 v15, 64, v14
    s_waitcnt lgkmcnt(0)
    s_barrier
    v_mfma_f32_32x32x16_bf16 v[212:227], v[52:55], v[20:23], 0
    ds_read_b128 v[36:39], v10
    ds_read_b64_tr_b16 v[100:101], v14 offset:0
    ds_read_b64_tr_b16 v[102:103], v14 offset:512
    v_mfma_f32_32x32x16_bf16 v[228:243], v[20:23], v[68:71], 0
    ds_read_b64_tr_b16 v[116:117], v15 offset:0
    ds_read_b64_tr_b16 v[118:119], v15 offset:512
    ds_read_b128 v[40:43], v11
    v_mfma_f32_32x32x16_bf16 v[212:227], v[56:59], v[24:27], v[212:227]
    ds_read_b64_tr_b16 v[104:105], v14 offset:2048
    ds_read_b64_tr_b16 v[106:107], v14 offset:2560
    ds_read_b64_tr_b16 v[120:121], v15 offset:2048
    v_mfma_f32_32x32x16_bf16 v[228:243], v[24:27], v[72:75], v[228:243]
    ds_read_b64_tr_b16 v[122:123], v15 offset:2560
    ds_read_b128 v[44:47], v12
    ds_read_b64_tr_b16 v[108:109], v14 offset:4096
    v_mfma_f32_32x32x16_bf16 v[212:227], v[60:63], v[28:31], v[212:227]
    ds_read_b64_tr_b16 v[110:111], v14 offset:4608
    ds_read_b64_tr_b16 v[124:125], v15 offset:4096
    s_waitcnt lgkmcnt(7)
    ds_read_b64_tr_b16 v[126:127], v15 offset:4608
    v_mfma_f32_32x32x16_bf16 v[228:243], v[28:31], v[76:79], v[228:243]
    ds_read_b128 v[48:51], v13
    ds_read_b64_tr_b16 v[112:113], v14 offset:6144
    ds_read_b64_tr_b16 v[114:115], v14 offset:6656
    v_mfma_f32_32x32x16_bf16 v[212:227], v[64:67], v[32:35], v[212:227]
    ds_read_b64_tr_b16 v[128:129], v15 offset:6144
    ds_read_b64_tr_b16 v[130:131], v15 offset:6656
    v_mfma_f32_32x32x16_bf16 v[228:243], v[32:35], v[80:83], v[228:243]
    v_add_u32 v10, 52224, v9
    v_xor_b32 v11, 32, v10
    v_xor_b32 v12, 64, v10
    v_xor_b32 v13, 96, v10
    v_add_u32 v14, 68608, v19
    v_xor_b32 v15, 64, v14
    s_waitcnt lgkmcnt(0)
    s_barrier
    v_mfma_f32_32x32x16_bf16 v[212:227], v[100:103], v[36:39], v[212:227]
    ds_read_b128 v[20:23], v10
    ds_read_b64_tr_b16 v[52:53], v14 offset:0
    ds_read_b64_tr_b16 v[54:55], v14 offset:512
    v_mfma_f32_32x32x16_bf16 v[228:243], v[36:39], v[116:119], v[228:243]
    ds_read_b64_tr_b16 v[68:69], v15 offset:0
    ds_read_b64_tr_b16 v[70:71], v15 offset:512
    ds_read_b128 v[24:27], v11
    v_mfma_f32_32x32x16_bf16 v[212:227], v[104:107], v[40:43], v[212:227]
    ds_read_b64_tr_b16 v[56:57], v14 offset:2048
    ds_read_b64_tr_b16 v[58:59], v14 offset:2560
    ds_read_b64_tr_b16 v[72:73], v15 offset:2048
    v_mfma_f32_32x32x16_bf16 v[228:243], v[40:43], v[120:123], v[228:243]
    ds_read_b64_tr_b16 v[74:75], v15 offset:2560
    ds_read_b128 v[28:31], v12
    ds_read_b64_tr_b16 v[60:61], v14 offset:4096
    v_mfma_f32_32x32x16_bf16 v[212:227], v[108:111], v[44:47], v[212:227]
    ds_read_b64_tr_b16 v[62:63], v14 offset:4608
    ds_read_b64_tr_b16 v[76:77], v15 offset:4096
    s_waitcnt lgkmcnt(7)
    ds_read_b64_tr_b16 v[78:79], v15 offset:4608
    v_mfma_f32_32x32x16_bf16 v[228:243], v[44:47], v[124:127], v[228:243]
    ds_read_b128 v[32:35], v13
    ds_read_b64_tr_b16 v[64:65], v14 offset:6144
    ds_read_b64_tr_b16 v[66:67], v14 offset:6656
    v_mfma_f32_32x32x16_bf16 v[212:227], v[112:115], v[48:51], v[212:227]
    ds_read_b64_tr_b16 v[80:81], v15 offset:6144
    ds_read_b64_tr_b16 v[82:83], v15 offset:6656
    v_mfma_f32_32x32x16_bf16 v[228:243], v[48:51], v[128:131], v[228:243]
    v_add_u32 v10, 76800, v9
    v_xor_b32 v11, 32, v10
    v_xor_b32 v12, 64, v10
    v_xor_b32 v13, 96, v10
    v_add_u32 v14, 93184, v19
    v_xor_b32 v15, 64, v14
    s_waitcnt lgkmcnt(0)
    s_barrier
    v_mfma_f32_32x32x16_bf16 v[212:227], v[52:55], v[20:23], v[212:227]
    ds_read_b128 v[36:39], v10
    ds_read_b64_tr_b16 v[100:101], v14 offset:0
    ds_read_b64_tr_b16 v[102:103], v14 offset:512
    v_mfma_f32_32x32x16_bf16 v[228:243], v[20:23], v[68:71], v[228:243]
    ds_read_b64_tr_b16 v[116:117], v15 offset:0
    ds_read_b64_tr_b16 v[118:119], v15 offset:512
    ds_read_b128 v[40:43], v11
    v_mfma_f32_32x32x16_bf16 v[212:227], v[56:59], v[24:27], v[212:227]
    ds_read_b64_tr_b16 v[104:105], v14 offset:2048
    ds_read_b64_tr_b16 v[106:107], v14 offset:2560
    ds_read_b64_tr_b16 v[120:121], v15 offset:2048
    v_mfma_f32_32x32x16_bf16 v[228:243], v[24:27], v[72:75], v[228:243]
    ds_read_b64_tr_b16 v[122:123], v15 offset:2560
    ds_read_b128 v[44:47], v12
    ds_read_b64_tr_b16 v[108:109], v14 offset:4096
    v_mfma_f32_32x32x16_bf16 v[212:227], v[60:63], v[28:31], v[212:227]
    ds_read_b64_tr_b16 v[110:111], v14 offset:4608
    ds_read_b64_tr_b16 v[124:125], v15 offset:4096
    s_waitcnt lgkmcnt(7)
    ds_read_b64_tr_b16 v[126:127], v15 offset:4608
    v_mfma_f32_32x32x16_bf16 v[228:243], v[28:31], v[76:79], v[228:243]
    ds_read_b128 v[48:51], v13
    ds_read_b64_tr_b16 v[112:113], v14 offset:6144
    ds_read_b64_tr_b16 v[114:115], v14 offset:6656
    v_mfma_f32_32x32x16_bf16 v[212:227], v[64:67], v[32:35], v[212:227]
    ds_read_b64_tr_b16 v[128:129], v15 offset:6144
    ds_read_b64_tr_b16 v[130:131], v15 offset:6656
    v_mfma_f32_32x32x16_bf16 v[228:243], v[32:35], v[80:83], v[228:243]
    v_add_u32 v10, 3072, v9
    v_xor_b32 v11, 32, v10
    v_xor_b32 v12, 64, v10
    v_xor_b32 v13, 96, v10
    v_add_u32 v14, 19456, v19
    v_xor_b32 v15, 64, v14
    s_waitcnt lgkmcnt(0)
    s_barrier
    v_mfma_f32_32x32x16_bf16 v[212:227], v[100:103], v[36:39], v[212:227]
    ds_read_b128 v[20:23], v10
    ds_read_b64_tr_b16 v[52:53], v14 offset:0
    ds_read_b64_tr_b16 v[54:55], v14 offset:512
    v_mfma_f32_32x32x16_bf16 v[228:243], v[36:39], v[116:119], v[228:243]
    ds_read_b64_tr_b16 v[68:69], v15 offset:0
    ds_read_b64_tr_b16 v[70:71], v15 offset:512
    ds_read_b128 v[24:27], v11
    v_mfma_f32_32x32x16_bf16 v[212:227], v[104:107], v[40:43], v[212:227]
    ds_read_b64_tr_b16 v[56:57], v14 offset:2048
    ds_read_b64_tr_b16 v[58:59], v14 offset:2560
    ds_read_b64_tr_b16 v[72:73], v15 offset:2048
    v_mfma_f32_32x32x16_bf16 v[228:243], v[40:43], v[120:123], v[228:243]
    ds_read_b64_tr_b16 v[74:75], v15 offset:2560
    ds_read_b128 v[28:31], v12
    ds_read_b64_tr_b16 v[60:61], v14 offset:4096
    v_mfma_f32_32x32x16_bf16 v[212:227], v[108:111], v[44:47], v[212:227]
    ds_read_b64_tr_b16 v[62:63], v14 offset:4608
    ds_read_b64_tr_b16 v[76:77], v15 offset:4096
    s_waitcnt lgkmcnt(7)
    ds_read_b64_tr_b16 v[78:79], v15 offset:4608
    v_mfma_f32_32x32x16_bf16 v[228:243], v[44:47], v[124:127], v[228:243]
    ds_read_b128 v[32:35], v13
    ds_read_b64_tr_b16 v[64:65], v14 offset:6144
    ds_read_b64_tr_b16 v[66:67], v14 offset:6656
    v_mfma_f32_32x32x16_bf16 v[212:227], v[112:115], v[48:51], v[212:227]
    ds_read_b64_tr_b16 v[80:81], v15 offset:6144
    ds_read_b64_tr_b16 v[82:83], v15 offset:6656
    v_mfma_f32_32x32x16_bf16 v[228:243], v[48:51], v[128:131], v[228:243]
    v_add_u32 v10, 27648, v9
    v_xor_b32 v11, 32, v10
    v_xor_b32 v12, 64, v10
    v_xor_b32 v13, 96, v10
    v_add_u32 v14, 44032, v19
    v_xor_b32 v15, 64, v14
    s_waitcnt lgkmcnt(0)
    s_barrier
    v_mfma_f32_32x32x16_bf16 v[212:227], v[52:55], v[20:23], v[212:227]
    ds_read_b128 v[36:39], v10
    ds_read_b64_tr_b16 v[100:101], v14 offset:0
    ds_read_b64_tr_b16 v[102:103], v14 offset:512
    v_mfma_f32_32x32x16_bf16 v[228:243], v[20:23], v[68:71], v[228:243]
    ds_read_b64_tr_b16 v[116:117], v15 offset:0
    ds_read_b64_tr_b16 v[118:119], v15 offset:512
    ds_read_b128 v[40:43], v11
    v_mfma_f32_32x32x16_bf16 v[212:227], v[56:59], v[24:27], v[212:227]
    ds_read_b64_tr_b16 v[104:105], v14 offset:2048
    ds_read_b64_tr_b16 v[106:107], v14 offset:2560
    ds_read_b64_tr_b16 v[120:121], v15 offset:2048
    buffer_load_dwordx4 v[148:151], v8, s[28:31], 0 offen sc1
    buffer_load_dwordx2 v[156:157], v7, s[28:31], 0 offen sc1
    buffer_load_dword v253, v6, s[28:31], 0 offen sc1
    v_mfma_f32_32x32x16_bf16 v[228:243], v[24:27], v[72:75], v[228:243]
    ds_read_b64_tr_b16 v[122:123], v15 offset:2560
    ds_read_b128 v[44:47], v12
    ds_read_b64_tr_b16 v[108:109], v14 offset:4096
    v_mfma_f32_32x32x16_bf16 v[212:227], v[60:63], v[28:31], v[212:227]
    ds_read_b64_tr_b16 v[110:111], v14 offset:4608
    ds_read_b64_tr_b16 v[124:125], v15 offset:4096
    s_waitcnt lgkmcnt(7)
    ds_read_b64_tr_b16 v[126:127], v15 offset:4608
    v_mfma_f32_32x32x16_bf16 v[228:243], v[28:31], v[76:79], v[228:243]
    ds_read_b128 v[48:51], v13
    ds_read_b64_tr_b16 v[112:113], v14 offset:6144
    ds_read_b64_tr_b16 v[114:115], v14 offset:6656
    v_mfma_f32_32x32x16_bf16 v[212:227], v[64:67], v[32:35], v[212:227]
    ds_read_b64_tr_b16 v[128:129], v15 offset:6144
    ds_read_b64_tr_b16 v[130:131], v15 offset:6656
    v_mfma_f32_32x32x16_bf16 v[228:243], v[32:35], v[80:83], v[228:243]
    v_add_u32 v10, 52224, v9
    v_xor_b32 v11, 32, v10
    v_xor_b32 v12, 64, v10
    v_xor_b32 v13, 96, v10
    v_add_u32 v14, 68608, v19
    v_xor_b32 v15, 64, v14
    s_waitcnt lgkmcnt(0)
    s_barrier
    v_mfma_f32_32x32x16_bf16 v[212:227], v[100:103], v[36:39], v[212:227]
    ds_read_b128 v[20:23], v10
    ds_read_b64_tr_b16 v[52:53], v14 offset:0
    ds_read_b64_tr_b16 v[54:55], v14 offset:512
    v_mfma_f32_32x32x16_bf16 v[228:243], v[36:39], v[116:119], v[228:243]
    ds_read_b64_tr_b16 v[68:69], v15 offset:0
    ds_read_b64_tr_b16 v[70:71], v15 offset:512
    ds_read_b128 v[24:27], v11
    v_mfma_f32_32x32x16_bf16 v[212:227], v[104:107], v[40:43], v[212:227]
    ds_read_b64_tr_b16 v[56:57], v14 offset:2048
    ds_read_b64_tr_b16 v[58:59], v14 offset:2560
    ds_read_b64_tr_b16 v[72:73], v15 offset:2048
    v_mfma_f32_32x32x16_bf16 v[228:243], v[40:43], v[120:123], v[228:243]
    ds_read_b64_tr_b16 v[74:75], v15 offset:2560
    ds_read_b128 v[28:31], v12
    ds_read_b64_tr_b16 v[60:61], v14 offset:4096
    v_mfma_f32_32x32x16_bf16 v[212:227], v[108:111], v[44:47], v[212:227]
    ds_read_b64_tr_b16 v[62:63], v14 offset:4608
    ds_read_b64_tr_b16 v[76:77], v15 offset:4096
    s_waitcnt lgkmcnt(7)
    ds_read_b64_tr_b16 v[78:79], v15 offset:4608
    v_mfma_f32_32x32x16_bf16 v[228:243], v[44:47], v[124:127], v[228:243]
    ds_read_b128 v[32:35], v13
    ds_read_b64_tr_b16 v[64:65], v14 offset:6144
    ds_read_b64_tr_b16 v[66:67], v14 offset:6656
    v_mfma_f32_32x32x16_bf16 v[212:227], v[112:115], v[48:51], v[212:227]
    ds_read_b64_tr_b16 v[80:81], v15 offset:6144
    ds_read_b64_tr_b16 v[82:83], v15 offset:6656
    v_mfma_f32_32x32x16_bf16 v[228:243], v[48:51], v[128:131], v[228:243]
    v_add_u32 v10, 76800, v9
    v_xor_b32 v11, 32, v10
    v_xor_b32 v12, 64, v10
    v_xor_b32 v13, 96, v10
    v_add_u32 v14, 93184, v19
    v_xor_b32 v15, 64, v14
    s_waitcnt lgkmcnt(0)
    s_barrier
    v_mfma_f32_32x32x16_bf16 v[212:227], v[52:55], v[20:23], v[212:227]
    ds_read_b128 v[36:39], v10
    ds_read_b64_tr_b16 v[100:101], v14 offset:0
    ds_read_b64_tr_b16 v[102:103], v14 offset:512
    v_mfma_f32_32x32x16_bf16 v[228:243], v[20:23], v[68:71], v[228:243]
    ds_read_b64_tr_b16 v[116:117], v15 offset:0
    ds_read_b64_tr_b16 v[118:119], v15 offset:512
    ds_read_b128 v[40:43], v11
    v_mfma_f32_32x32x16_bf16 v[212:227], v[56:59], v[24:27], v[212:227]
    ds_read_b64_tr_b16 v[104:105], v14 offset:2048
    ds_read_b64_tr_b16 v[106:107], v14 offset:2560
    ds_read_b64_tr_b16 v[120:121], v15 offset:2048
    v_min_u32 v17, 11, v1
    v_lshlrev_b32 v17, 7, v17
    s_lshl_b32 s62, s2, 2
    s_add_u32 s62, s62, s63
    s_mul_i32 s62, s62, 1536
    buffer_load_dword v254, v17, s[16:19], s62 offen
    s_lshl_b32 s62, s45, 2
    s_add_u32 s62, s62, s63
    s_lshl_b32 s62, s62, 12
    v_and_b32 v3, 31, v1
    v_lshlrev_b32 v3, 7, v3
    buffer_load_dword v255, v3, s[12:15], s62 offen
    v_bfe_u32 v250, v1, 2, 2
    v_min_u32 v250, 2, v250
    v_lshlrev_b32 v250, 13, v250
    v_and_b32 v251, 3, v1
    v_lshl_add_u32 v250, v251, 7, v250
    s_lshl_b32 s61, s46, 9
    s_add_u32 s61, s61, 40960
    buffer_load_dword v254, v250, s[28:31], s61 offen sc1
    s_lshl_b32 s62, s2, 2
    s_add_u32 s62, s62, s63
    s_mul_i32 s62, s62, 1536
    buffer_load_dword v254, v17, s[20:23], s62 offen
    v_bfe_u32 v250, v1, 2, 1
    v_lshlrev_b32 v250, 12, v250
    v_and_b32 v251, 3, v1
    v_lshl_add_u32 v250, v251, 7, v250
    s_lshl_b32 s61, s48, 13
    s_lshl_b32 s62, s49, 9
    s_add_u32 s61, s61, s62
    s_add_u32 s61, s61, 10485760
    buffer_load_dword v253, v250, s[28:31], s61 offen sc1
    v_mfma_f32_32x32x16_bf16 v[228:243], v[24:27], v[72:75], v[228:243]
    ds_read_b64_tr_b16 v[122:123], v15 offset:2560
    ds_read_b128 v[44:47], v12
    ds_read_b64_tr_b16 v[108:109], v14 offset:4096
    v_mfma_f32_32x32x16_bf16 v[212:227], v[60:63], v[28:31], v[212:227]
    ds_read_b64_tr_b16 v[110:111], v14 offset:4608
    ds_read_b64_tr_b16 v[124:125], v15 offset:4096
    s_waitcnt lgkmcnt(7)
    ds_read_b64_tr_b16 v[126:127], v15 offset:4608
    v_mfma_f32_32x32x16_bf16 v[228:243], v[28:31], v[76:79], v[228:243]
    ds_read_b128 v[48:51], v13
    ds_read_b64_tr_b16 v[112:113], v14 offset:6144
    ds_read_b64_tr_b16 v[114:115], v14 offset:6656
    v_mfma_f32_32x32x16_bf16 v[212:227], v[64:67], v[32:35], v[212:227]
    ds_read_b64_tr_b16 v[128:129], v15 offset:6144
    ds_read_b64_tr_b16 v[130:131], v15 offset:6656
    v_mfma_f32_32x32x16_bf16 v[228:243], v[32:35], v[80:83], v[228:243]
    s_waitcnt vmcnt(6)
    s_mov_b32 s55, 0
L_gr_49:
    v_cmp_ne_u32 vcc, s52, v149
    v_cmp_ne_u32 s[90:91], s52, v151
    s_or_b64 vcc, vcc, s[90:91]
    v_cmp_ne_u32 s[90:91], s52, v156
    s_or_b64 vcc, vcc, s[90:91]
    s_cbranch_vccnz L_grx_50
L_grd_51:
    v_readfirstlane_b32 s56, v157
    s_nop 1
    v_cmp_ne_u32 vcc, s56, v157
    s_cmp_eq_u64 vcc, 0
    s_cselect_b32 s53, 1, 0
    v_mov_b32 v10, 2564
    v_mov_b32 v11, s53
    ds_write_b32 v10, v11
    v_and_b32 v10, 31, v1
    v_lshlrev_b32 v10, 2, v10
    s_lshl_b32 s55, s51, 7
    v_add_u32 v11, s55, v10
    ds_write_b32 v11, v148 offset:0
    ds_write_b32 v11, v150 offset:512
    v_lshrrev_b32 v12, 5, v1
    v_lshlrev_b32 v12, 4, v12
    v_add_u32 v13, s55, v12
    s_waitcnt lgkmcnt(0)
    s_barrier
    ds_read_b128 v[68:71], v12 offset:1152
    ds_read_b128 v[72:75], v12 offset:1184
    ds_read_b128 v[76:79], v12 offset:1216
    ds_read_b128 v[80:83], v12 offset:1248
    ds_read_b32 v152, v10 offset:1280
    ds_read_b128 v[84:87], v13 offset:512
    ds_read_b128 v[88:91], v13 offset:544
    ds_read_b128 v[92:95], v13 offset:576
    ds_read_b128 v[96:99], v13 offset:608
    v_mfma_f32_32x32x16_bf16 v[212:227], v[100:103], v[36:39], v[212:227]
    ds_read_b128 v[20:23], v13 offset:0
    ds_read_b128 v[24:27], v13 offset:32
    ds_read_b128 v[28:31], v13 offset:64
    ds_read_b128 v[32:35], v13 offset:96
    v_mfma_f32_32x32x16_bf16 v[212:227], v[104:107], v[40:43], v[212:227]
    s_lshl_b32 s55, s51, 11
    s_add_u32 s56, s55, 84992
    v_add_u32 v15, s56, v2
    s_mul_i32 s55, s51, 2080
    s_add_u32 s55, s55, 109824
    v_add_u32 v16, s55, v2
    v_mfma_f32_32x32x16_bf16 v[212:227], v[108:111], v[44:47], v[212:227]
    s_waitcnt lgkmcnt(9)
    v_mul_f32 v68, v150, v68
    v_mul_f32 v69, v150, v69
    v_mul_f32 v70, v150, v70
    v_mul_f32 v71, v150, v71
    v_mul_f32 v72, v150, v72
    v_mul_f32 v73, v150, v73
    v_mul_f32 v74, v150, v74
    v_mul_f32 v75, v150, v75
    v_mfma_f32_32x32x16_bf16 v[212:227], v[112:115], v[48:51], v[212:227]
    v_mul_f32 v76, v150, v76
    v_mul_f32 v77, v150, v77
    v_mul_f32 v78, v150, v78
    v_mul_f32 v79, v150, v79
    v_mul_f32 v80, v150, v80
    v_mul_f32 v81, v150, v81
    v_mul_f32 v82, v150, v82
    v_mul_f32 v83, v150, v83
    v_mfma_f32_32x32x16_bf16 v[228:243], v[36:39], v[116:119], v[228:243]
    s_waitcnt lgkmcnt(4)
    v_mul_f32 v84, v152, v84
    v_mul_f32 v85, v152, v85
    v_mul_f32 v86, v152, v86
    v_mul_f32 v87, v152, v87
    v_mul_f32 v88, v152, v88
    v_mul_f32 v89, v152, v89
    v_mul_f32 v90, v152, v90
    v_mul_f32 v91, v152, v91
    v_mfma_f32_32x32x16_bf16 v[228:243], v[40:43], v[120:123], v[228:243]
    v_mul_f32 v92, v152, v92
    v_mul_f32 v93, v152, v93
    v_mul_f32 v94, v152, v94
    v_mul_f32 v95, v152, v95
    v_mul_f32 v96, v152, v96
    v_mul_f32 v97, v152, v97
    v_mul_f32 v98, v152, v98
    v_mul_f32 v99, v152, v99
    v_mfma_f32_32x32x16_bf16 v[228:243], v[44:47], v[124:127], v[228:243]
    v_fma_f32 v212, v212, v148, -v68
    v_fma_f32 v213, v213, v148, -v69
    v_fma_f32 v214, v214, v148, -v70
    v_fma_f32 v215, v215, v148, -v71
    v_fma_f32 v216, v216, v148, -v72
    v_fma_f32 v217, v217, v148, -v73
    v_fma_f32 v218, v218, v148, -v74
    v_fma_f32 v219, v219, v148, -v75
    v_mfma_f32_32x32x16_bf16 v[228:243], v[48:51], v[128:131], v[228:243]
    v_fma_f32 v220, v220, v148, -v76
    v_fma_f32 v221, v221, v148, -v77
    v_fma_f32 v222, v222, v148, -v78
    v_fma_f32 v223, v223, v148, -v79
    v_fma_f32 v224, v224, v148, -v80
    v_fma_f32 v225, v225, v148, -v81
    v_fma_f32 v226, v226, v148, -v82
    v_fma_f32 v227, v227, v148, -v83
    v_cvt_pk_bf16_f32 v244, v212, v213
    v_cvt_pk_bf16_f32 v245, v214, v215
    v_cvt_pk_bf16_f32 v246, v216, v217
    v_cvt_pk_bf16_f32 v247, v218, v219
    v_cvt_pk_bf16_f32 v248, v220, v221
    v_cvt_pk_bf16_f32 v249, v222, v223
    v_cvt_pk_bf16_f32 v250, v224, v225
    v_cvt_pk_bf16_f32 v251, v226, v227
    buffer_store_dwordx4 v[244:247], v2, s[28:31], s57 offen offset:0 sc1
    buffer_store_dwordx4 v[248:251], v2, s[28:31], s57 offen offset:1024 sc1
    s_waitcnt lgkmcnt(0)
    v_fma_f32 v228, v228, v20, -v84
    v_fma_f32 v229, v229, v21, -v85
    v_fma_f32 v230, v230, v22, -v86
    v_fma_f32 v231, v231, v23, -v87
    v_fma_f32 v232, v232, v24, -v88
    v_fma_f32 v233, v233, v25, -v89
    v_fma_f32 v234, v234, v26, -v90
    v_fma_f32 v235, v235, v27, -v91
    v_fma_f32 v236, v236, v28, -v92
    v_fma_f32 v237, v237, v29, -v93
    v_fma_f32 v238, v238, v30, -v94
    v_fma_f32 v239, v239, v31, -v95
    v_fma_f32 v240, v240, v32, -v96
    v_fma_f32 v241, v241, v33, -v97
    v_fma_f32 v242, v242, v34, -v98
    v_fma_f32 v243, v243, v35, -v99
    v_cvt_pk_bf16_f32 v52, v228, v229
    v_cvt_pk_bf16_f32 v53, v230, v231
    v_cvt_pk_bf16_f32 v54, v232, v233
    v_cvt_pk_bf16_f32 v55, v234, v235
    v_cvt_pk_bf16_f32 v56, v236, v237
    v_cvt_pk_bf16_f32 v57, v238, v239
    v_cvt_pk_bf16_f32 v58, v240, v241
    v_cvt_pk_bf16_f32 v59, v242, v243
    buffer_store_dwordx4 v[52:55], v2, s[28:31], s57 offen offset:2048 sc1
    buffer_store_dwordx4 v[56:59], v2, s[28:31], s57 offen offset:3072 sc1
    ds_write_b128 v15, v[244:247] offset:0
    ds_write_b128 v16, v[52:55] offset:0
    ds_write_b128 v15, v[248:251] offset:1024
    ds_write_b128 v16, v[56:59] offset:1040
    s_lshl_b32 s55, s51, 10
    s_add_u32 s55, s55, 151552
    v_add_u32 v12, s55, v2
    v_mov_b32 v102, 0
    v_mov_b32 v103, 1
    s_mov_b64 exec, 1
    ds_add_u32 v102, v103 offset:2856
    s_mov_b64 exec, -1
    s_lshl_b32 s55, s51, 11
    s_lshl_b32 s56, s54, 10
    s_add_u32 s55, s55, s56
    s_add_u32 s55, s55, 68608
    v_add_u32 v100, s55, v2
    v_and_b32 v10, 47, v1
    s_lshl_b32 s56, s54, 4
    v_add_u32 v10, s56, v10
    v_lshlrev_b32 v10, 4, v10
    v_and_b32 v11, 16, v1
    v_cmp_ne_u32 vcc, 0, v11
    v_mov_b32 v11, 1024
    s_nop 0
    v_cndmask_b32 v10, v10, v11, vcc
    s_mul_i32 s55, s51, 2080
    s_add_u32 s55, s55, 93184
    v_add_u32 v101, s55, v10
    v_mov_b32 v10, s59
    v_mov_b32 v11, s52
    s_waitcnt vmcnt(0)
    s_mov_b64 exec, 1
    buffer_store_dword v11, v10, s[28:31], 0 offen sc1
    s_mov_b64 exec, -1
    s_mov_b64 exec, 1
    ds_add_u32 v102, v103 offset:2864
    s_mov_b64 exec, -1
    v_mov_b32 v13, v12
    ds_read_b32 v10, v102 offset:2852
    s_waitcnt lgkmcnt(0)
    v_cmp_gt_u32 vcc, 4, v10
    s_cbranch_vccnz L_lwx_53
L_lw_52:
    ds_read_b32 v10, v102 offset:2856
    s_waitcnt lgkmcnt(0)
    v_cmp_gt_u32 vcc, 4, v10
    s_cbranch_vccnz L_lwx_55
L_lw_54:
    ds_read_b128 v[160:163], v13
    ds_read_b128 v[60:63], v100 offset:16384
    ds_read_b128 v[68:71], v101 offset:16640
    ds_read_b128 v[72:75], v101 offset:17680
    s_waitcnt lgkmcnt(2)
    v_mfma_f32_32x32x16_bf16 v[20:35], v[60:63], v[160:163], v[164:179]
    ds_read_b128 v[64:67], v100 offset:14336
    ds_read_b128 v[76:79], v101 offset:14560
    ds_read_b128 v[80:83], v101 offset:15600
    s_nop 8
    v_exp_f32 v20, v20
    v_exp_f32 v21, v21
    v_exp_f32 v22, v22
    v_exp_f32 v23, v23
    v_exp_f32 v24, v24
    v_exp_f32 v25, v25
    v_exp_f32 v26, v26
    v_exp_f32 v27, v27
    s_waitcnt lgkmcnt(2)
    v_mfma_f32_32x32x16_bf16 v[36:51], v[64:67], v[160:163], 0
    v_cvt_pk_bf16_f32 v52, v20, v21
    v_cvt_pk_bf16_f32 v53, v22, v23
    v_cvt_pk_bf16_f32 v54, v24, v25
    v_cvt_pk_bf16_f32 v55, v26, v27
    s_nop 1
    v_mfma_f32_32x32x16_bf16 v[84:99], v[68:71], v[52:55], 0
    v_exp_f32 v28, v28
    v_exp_f32 v29, v29
    v_exp_f32 v30, v30
    v_exp_f32 v31, v31
    v_exp_f32 v32, v32
    v_exp_f32 v33, v33
    v_exp_f32 v34, v34
    v_exp_f32 v35, v35
    v_cvt_pk_bf16_f32 v56, v28, v29
    v_cvt_pk_bf16_f32 v57, v30, v31
    v_cvt_pk_bf16_f32 v58, v32, v33
    v_cvt_pk_bf16_f32 v59, v34, v35
    s_nop 1
    v_mfma_f32_32x32x16_bf16 v[84:99], v[72:75], v[56:59], v[84:99]
    s_cmp_eq_u32 s51, 0
    s_cbranch_scc1 L_2a_done_56
    ds_read_b128 v[60:63], v100 offset:12288
    ds_read_b128 v[68:71], v101 offset:12480
    ds_read_b128 v[72:75], v101 offset:13520
    v_exp_f32 v36, v36
    v_exp_f32 v37, v37
    v_exp_f32 v38, v38
    v_exp_f32 v39, v39
    v_exp_f32 v40, v40
    v_exp_f32 v41, v41
    v_exp_f32 v42, v42
    v_exp_f32 v43, v43
    s_waitcnt lgkmcnt(2)
    v_mfma_f32_32x32x16_bf16 v[20:35], v[60:63], v[160:163], 0
    v_cvt_pk_bf16_f32 v52, v36, v37
    v_cvt_pk_bf16_f32 v53, v38, v39
    v_cvt_pk_bf16_f32 v54, v40, v41
    v_cvt_pk_bf16_f32 v55, v42, v43
    s_nop 1
    v_mfma_f32_32x32x16_bf16 v[84:99], v[76:79], v[52:55], v[84:99]
    v_exp_f32 v44, v44
    v_exp_f32 v45, v45
    v_exp_f32 v46, v46
    v_exp_f32 v47, v47
    v_exp_f32 v48, v48
    v_exp_f32 v49, v49
    v_exp_f32 v50, v50
    v_exp_f32 v51, v51
    v_cvt_pk_bf16_f32 v56, v44, v45
    v_cvt_pk_bf16_f32 v57, v46, v47
    v_cvt_pk_bf16_f32 v58, v48, v49
    v_cvt_pk_bf16_f32 v59, v50, v51
    s_nop 1
    v_mfma_f32_32x32x16_bf16 v[84:99], v[80:83], v[56:59], v[84:99]
    s_cmp_eq_u32 s51, 1
    s_cbranch_scc1 L_2a_done_56
    ds_read_b128 v[64:67], v100 offset:10240
    ds_read_b128 v[76:79], v101 offset:10400
    ds_read_b128 v[80:83], v101 offset:11440
    v_exp_f32 v20, v20
    v_exp_f32 v21, v21
    v_exp_f32 v22, v22
    v_exp_f32 v23, v23
    v_exp_f32 v24, v24
    v_exp_f32 v25, v25
    v_exp_f32 v26, v26
    v_exp_f32 v27, v27
    s_waitcnt lgkmcnt(2)
    v_mfma_f32_32x32x16_bf16 v[36:51], v[64:67], v[160:163], 0
    v_cvt_pk_bf16_f32 v52, v20, v21
    v_cvt_pk_bf16_f32 v53, v22, v23
    v_cvt_pk_bf16_f32 v54, v24, v25
    v_cvt_pk_bf16_f32 v55, v26, v27
    s_nop 1
    v_mfma_f32_32x32x16_bf16 v[84:99], v[68:71], v[52:55], v[84:99]
    v_exp_f32 v28, v28
    v_exp_f32 v29, v29
    v_exp_f32 v30, v30
    v_exp_f32 v31, v31
    v_exp_f32 v32, v32
    v_exp_f32 v33, v33
    v_exp_f32 v34, v34
    v_exp_f32 v35, v35
    v_cvt_pk_bf16_f32 v56, v28, v29
    v_cvt_pk_bf16_f32 v57, v30, v31
    v_cvt_pk_bf16_f32 v58, v32, v33
    v_cvt_pk_bf16_f32 v59, v34, v35
    s_nop 1
    v_mfma_f32_32x32x16_bf16 v[84:99], v[72:75], v[56:59], v[84:99]
    s_cmp_eq_u32 s51, 2
    s_cbranch_scc1 L_2a_done_56
    v_exp_f32 v36, v36
    v_exp_f32 v37, v37
    v_exp_f32 v38, v38
    v_exp_f32 v39, v39
    v_exp_f32 v40, v40
    v_exp_f32 v41, v41
    v_exp_f32 v42, v42
    v_exp_f32 v43, v43
    v_cvt_pk_bf16_f32 v52, v36, v37
    v_cvt_pk_bf16_f32 v53, v38, v39
    v_cvt_pk_bf16_f32 v54, v40, v41
    v_cvt_pk_bf16_f32 v55, v42, v43
    s_waitcnt lgkmcnt(0)
    s_nop 0
    v_mfma_f32_32x32x16_bf16 v[84:99], v[76:79], v[52:55], v[84:99]
    v_exp_f32 v44, v44
    v_exp_f32 v45, v45
    v_exp_f32 v46, v46
    v_exp_f32 v47, v47
    v_exp_f32 v48, v48
    v_exp_f32 v49, v49
    v_exp_f32 v50, v50
    v_exp_f32 v51, v51
    v_cvt_pk_bf16_f32 v56, v44, v45
    v_cvt_pk_bf16_f32 v57, v46, v47
    v_cvt_pk_bf16_f32 v58, v48, v49
    v_cvt_pk_bf16_f32 v59, v50, v51
    s_nop 1
    v_mfma_f32_32x32x16_bf16 v[84:99], v[80:83], v[56:59], v[84:99]
L_2a_done_56:
    s_waitcnt lgkmcnt(0)
    s_add_u32 s58, s60, 262144
    v_subrev_u32 v15, 16384, v15
    v_subrev_u32 v16, 16640, v16
    s_mov_b32 s55, 0
L_poll_57:
    buffer_load_dword v11, v6, s[28:31], 0 offen sc1
    s_waitcnt vmcnt(0)
    v_cmp_ne_u32 vcc, s52, v11
    s_cbranch_vccnz L_pollx_59
L_polld_58:
    buffer_load_dwordx4 v[136:139], v2, s[28:31], s58 offen offset:0 sc1
    buffer_load_dwordx4 v[140:143], v2, s[28:31], s58 offen offset:1024 sc1
    buffer_load_dwordx4 v[144:147], v2, s[28:31], s58 offen offset:2048 sc1
    buffer_load_dwordx4 v[148:151], v2, s[28:31], s58 offen offset:3072 sc1
    buffer_load_dwordx4 v[120:123], v2, s[28:31], s60 offen offset:0 sc1
    buffer_load_dwordx4 v[124:127], v2, s[28:31], s60 offen offset:1024 sc1
    buffer_load_dwordx4 v[128:131], v2, s[28:31], s60 offen offset:2048 sc1
    buffer_load_dwordx4 v[132:135], v2, s[28:31], s60 offen offset:3072 sc1
    s_mov_b64 exec, 1
    ds_add_u32 v102, v103 offset:2860
    s_mov_b64 exec, -1
    v_and_b32 v10, 31, v1
    s_lshl_b32 s55, s48, 1
    s_add_u32 s64, s55, s94
    s_lshl_b32 s55, s64, 5
    v_add_u32 v10, s55, v10
    v_lshlrev_b32 v10, 10, v10
    v_lshrrev_b32 v11, 5, v1
    v_lshl_add_u32 v10, v11, 3, v10
    s_lshl_b32 s55, s49, 7
    s_lshl_b32 s56, s95, 6
    s_add_u32 s55, s55, s56
    v_add_u32 v9, s55, v10
    s_mov_b32 s55, 0
L_zc_62:
    s_cmp_lt_u32 s46, 2
    s_cbranch_scc1 L_nohalo_60
L_halow_61:
    s_waitcnt vmcnt(7)
    ds_write_b128 v15, v[136:139] offset:8192
    s_waitcnt vmcnt(6)
    ds_write_b128 v15, v[140:143] offset:9216
    s_waitcnt vmcnt(5)
    ds_write_b128 v16, v[144:147] offset:8320
    s_waitcnt vmcnt(4)
    ds_write_b128 v16, v[148:151] offset:9360
    s_waitcnt vmcnt(3)
    ds_write_b128 v15, v[120:123] offset:0
    s_waitcnt vmcnt(2)
    ds_write_b128 v15, v[124:127] offset:1024
    s_waitcnt vmcnt(1)
    ds_write_b128 v16, v[128:131] offset:0
    s_waitcnt vmcnt(0)
    ds_write_b128 v16, v[132:135] offset:1040
    s_add_u32 s59, s59, 16
    v_mov_b32 v10, s59
    v_mov_b32 v11, s52
    s_mov_b64 exec, 1
    buffer_store_dword v11, v10, s[28:31], 0 offen sc1
    s_mov_b64 exec, -1
    buffer_load_dwordx2 v[240:241], v9, s[4:7], 0 offen offset:0
    buffer_load_dwordx2 v[242:243], v9, s[4:7], 0 offen offset:16
    buffer_load_dwordx2 v[244:245], v9, s[4:7], 0 offen offset:32
    buffer_load_dwordx2 v[246:247], v9, s[4:7], 0 offen offset:48
    v_bfe_u32 v10, v1, 2, 2
    v_lshrrev_b32 v11, 5, v1
    v_lshl_add_u32 v10, v11, 2, v10
    v_lshlrev_b32 v10, 7, v10
    v_bfe_u32 v11, v1, 4, 1
    v_lshl_add_u32 v10, v11, 5, v10
    v_and_b32 v11, 3, v1
    v_lshl_add_u32 v10, v11, 3, v10
    v_bfe_u32 v11, v1, 3, 1
    v_lshl_add_u32 v4, v11, 6, v10
    v_xor_b32 v5, 64, v4
    s_lshl_b32 s55, s95, 6
    v_xor_b32 v4, s55, v4
    v_xor_b32 v5, s55, v5
    s_lshl_b32 s55, s95, 15
    s_add_u32 s55, s55, 3072
    v_add_u32 v6, s55, v4
    v_add_u32 v7, s55, v5
    s_waitcnt lgkmcnt(0)
    s_barrier
    s_max_i32 s55, s46, 1
    s_sub_u32 s55, s55, 1
    s_lshl_b32 s55, s55, 4
    s_add_u32 s55, s55, s47
    s_lshl_b32 s55, s55, 7
    s_add_u32 s55, s55, 8208
    v_and_b32 v102, 3, v1
    v_lshlrev_b32 v102, 2, v102
    v_add_u32 v102, s55, v102
    ds_read_b128 v[60:63], v100 offset:0
    ds_read_b128 v[68:71], v101 offset:0
    ds_read_b128 v[72:75], v101 offset:1040
    s_waitcnt lgkmcnt(2)
    v_mfma_f32_32x32x16_bf16 v[20:35], v[60:63], v[160:163], v[180:195]
    ds_read_b128 v[64:67], v100 offset:2048
    ds_read_b128 v[76:79], v101 offset:2080
    ds_read_b128 v[80:83], v101 offset:3120
    s_nop 8
    v_exp_f32 v20, v20
    v_exp_f32 v21, v21
    v_exp_f32 v22, v22
    v_exp_f32 v23, v23
    v_exp_f32 v24, v24
    v_exp_f32 v25, v25
    v_exp_f32 v26, v26
    v_exp_f32 v27, v27
    s_waitcnt lgkmcnt(2)
    v_mfma_f32_32x32x16_bf16 v[36:51], v[64:67], v[160:163], 0
    v_cvt_pk_bf16_f32 v52, v20, v21
    v_cvt_pk_bf16_f32 v53, v22, v23
    v_cvt_pk_bf16_f32 v54, v24, v25
    v_cvt_pk_bf16_f32 v55, v26, v27
    s_nop 1
    v_mfma_f32_32x32x16_bf16 v[84:99], v[68:71], v[52:55], v[84:99]
    v_exp_f32 v28, v28
    v_exp_f32 v29, v29
    v_exp_f32 v30, v30
    v_exp_f32 v31, v31
    v_exp_f32 v32, v32
    v_exp_f32 v33, v33
    v_exp_f32 v34, v34
    v_exp_f32 v35, v35
    v_cvt_pk_bf16_f32 v56, v28, v29
    v_cvt_pk_bf16_f32 v57, v30, v31
    v_cvt_pk_bf16_f32 v58, v32, v33
    v_cvt_pk_bf16_f32 v59, v34, v35
    s_nop 1
    v_mfma_f32_32x32x16_bf16 v[84:99], v[72:75], v[56:59], v[84:99]
    ds_read_b128 v[60:63], v100 offset:4096
    ds_read_b128 v[68:71], v101 offset:4160
    ds_read_b128 v[72:75], v101 offset:5200
    v_exp_f32 v36, v36
    v_exp_f32 v37, v37
    v_exp_f32 v38, v38
    v_exp_f32 v39, v39
    v_exp_f32 v40, v40
    v_exp_f32 v41, v41
    v_exp_f32 v42, v42
    v_exp_f32 v43, v43
    s_waitcnt lgkmcnt(2)
    v_mfma_f32_32x32x16_bf16 v[20:35], v[60:63], v[160:163], 0
    v_cvt_pk_bf16_f32 v52, v36, v37
    v_cvt_pk_bf16_f32 v53, v38, v39
    v_cvt_pk_bf16_f32 v54, v40, v41
    v_cvt_pk_bf16_f32 v55, v42, v43
    s_nop 1
    v_mfma_f32_32x32x16_bf16 v[84:99], v[76:79], v[52:55], v[84:99]
    v_exp_f32 v44, v44
    v_exp_f32 v45, v45
    v_exp_f32 v46, v46
    v_exp_f32 v47, v47
    v_exp_f32 v48, v48
    v_exp_f32 v49, v49
    v_exp_f32 v50, v50
    v_exp_f32 v51, v51
    v_cvt_pk_bf16_f32 v56, v44, v45
    v_cvt_pk_bf16_f32 v57, v46, v47
    v_cvt_pk_bf16_f32 v58, v48, v49
    v_cvt_pk_bf16_f32 v59, v50, v51
    s_nop 1
    v_mfma_f32_32x32x16_bf16 v[84:99], v[80:83], v[56:59], v[84:99]
    ds_read_b128 v[64:67], v100 offset:6144
    ds_read_b128 v[76:79], v101 offset:6240
    ds_read_b128 v[80:83], v101 offset:7280
    v_exp_f32 v20, v20
    v_exp_f32 v21, v21
    v_exp_f32 v22, v22
    v_exp_f32 v23, v23
    v_exp_f32 v24, v24
    v_exp_f32 v25, v25
    v_exp_f32 v26, v26
    v_exp_f32 v27, v27
    s_waitcnt lgkmcnt(2)
    v_mfma_f32_32x32x16_bf16 v[36:51], v[64:67], v[160:163], 0
    v_cvt_pk_bf16_f32 v52, v20, v21
    v_cvt_pk_bf16_f32 v53, v22, v23
    v_cvt_pk_bf16_f32 v54, v24, v25
    v_cvt_pk_bf16_f32 v55, v26, v27
    s_nop 1
    v_mfma_f32_32x32x16_bf16 v[84:99], v[68:71], v[52:55], v[84:99]
    v_exp_f32 v28, v28
    v_exp_f32 v29, v29
    v_exp_f32 v30, v30
    v_exp_f32 v31, v31
    v_exp_f32 v32, v32
    v_exp_f32 v33, v33
    v_exp_f32 v34, v34
    v_exp_f32 v35, v35
    v_cvt_pk_bf16_f32 v56, v28, v29
    v_cvt_pk_bf16_f32 v57, v30, v31
    v_cvt_pk_bf16_f32 v58, v32, v33
    v_cvt_pk_bf16_f32 v59, v34, v35
    s_nop 1
    v_mfma_f32_32x32x16_bf16 v[84:99], v[72:75], v[56:59], v[84:99]
    ds_read_b128 v[60:63], v100 offset:8192
    ds_read_b128 v[68:71], v101 offset:8320
    ds_read_b128 v[72:75], v101 offset:9360
    v_exp_f32 v36, v36
    v_exp_f32 v37, v37
    v_exp_f32 v38, v38
    v_exp_f32 v39, v39
    v_exp_f32 v40, v40
    v_exp_f32 v41, v41
    v_exp_f32 v42, v42
    v_exp_f32 v43, v43
    s_waitcnt lgkmcnt(2)
    v_mfma_f32_32x32x16_bf16 v[20:35], v[60:63], v[160:163], 0
    v_cvt_pk_bf16_f32 v52, v36, v37
    v_cvt_pk_bf16_f32 v53, v38, v39
    v_cvt_pk_bf16_f32 v54, v40, v41
    v_cvt_pk_bf16_f32 v55, v42, v43
    s_nop 1
    v_mfma_f32_32x32x16_bf16 v[84:99], v[76:79], v[52:55], v[84:99]
    v_exp_f32 v44, v44
    v_exp_f32 v45, v45
    v_exp_f32 v46, v46
    v_exp_f32 v47, v47
    v_exp_f32 v48, v48
    v_exp_f32 v49, v49
    v_exp_f32 v50, v50
    v_exp_f32 v51, v51
    v_cvt_pk_bf16_f32 v56, v44, v45
    v_cvt_pk_bf16_f32 v57, v46, v47
    v_cvt_pk_bf16_f32 v58, v48, v49
    v_cvt_pk_bf16_f32 v59, v50, v51
    s_nop 1
    v_mfma_f32_32x32x16_bf16 v[84:99], v[80:83], v[56:59], v[84:99]
    ds_read_b128 v[64:67], v100 offset:10240
    ds_read_b128 v[76:79], v101 offset:10400
    ds_read_b128 v[80:83], v101 offset:11440
    v_exp_f32 v20, v20
    v_exp_f32 v21, v21
    v_exp_f32 v22, v22
    v_exp_f32 v23, v23
    v_exp_f32 v24, v24
    v_exp_f32 v25, v25
    v_exp_f32 v26, v26
    v_exp_f32 v27, v27
    buffer_load_dword v103, v102, s[28:31], 0 offen sc1
    s_waitcnt lgkmcnt(2)
    v_mfma_f32_32x32x16_bf16 v[36:51], v[64:67], v[160:163], 0
    v_cvt_pk_bf16_f32 v52, v20, v21
    v_cvt_pk_bf16_f32 v53, v22, v23
    v_cvt_pk_bf16_f32 v54, v24, v25
    v_cvt_pk_bf16_f32 v55, v26, v27
    s_nop 1
    v_mfma_f32_32x32x16_bf16 v[84:99], v[68:71], v[52:55], v[84:99]
    v_exp_f32 v28, v28
    v_exp_f32 v29, v29
    v_exp_f32 v30, v30
    v_exp_f32 v31, v31
    v_exp_f32 v32, v32
    v_exp_f32 v33, v33
    v_exp_f32 v34, v34
    v_exp_f32 v35, v35
    v_cvt_pk_bf16_f32 v56, v28, v29
    v_cvt_pk_bf16_f32 v57, v30, v31
    v_cvt_pk_bf16_f32 v58, v32, v33
    v_cvt_pk_bf16_f32 v59, v34, v35
    s_nop 1
    v_mfma_f32_32x32x16_bf16 v[84:99], v[72:75], v[56:59], v[84:99]
    s_cmp_eq_u32 s51, 3
    s_cbranch_scc1 L_2b_done_63
    ds_read_b128 v[60:63], v100 offset:12288
    ds_read_b128 v[68:71], v101 offset:12480
    ds_read_b128 v[72:75], v101 offset:13520
    v_exp_f32 v36, v36
    v_exp_f32 v37, v37
    v_exp_f32 v38, v38
    v_exp_f32 v39, v39
    v_exp_f32 v40, v40
    v_exp_f32 v41, v41
    v_exp_f32 v42, v42
    v_exp_f32 v43, v43
    s_waitcnt lgkmcnt(2)
    v_mfma_f32_32x32x16_bf16 v[20:35], v[60:63], v[160:163], 0
    v_cvt_pk_bf16_f32 v52, v36, v37
    v_cvt_pk_bf16_f32 v53, v38, v39
    v_cvt_pk_bf16_f32 v54, v40, v41
    v_cvt_pk_bf16_f32 v55, v42, v43
    s_nop 1
    v_mfma_f32_32x32x16_bf16 v[84:99], v[76:79], v[52:55], v[84:99]
    v_exp_f32 v44, v44
    v_exp_f32 v45, v45
    v_exp_f32 v46, v46
    v_exp_f32 v47, v47
    v_exp_f32 v48, v48
    v_exp_f32 v49, v49
    v_exp_f32 v50, v50
    v_exp_f32 v51, v51
    v_cvt_pk_bf16_f32 v56, v44, v45
    v_cvt_pk_bf16_f32 v57, v46, v47
    v_cvt_pk_bf16_f32 v58, v48, v49
    v_cvt_pk_bf16_f32 v59, v50, v51
    s_nop 1
    v_mfma_f32_32x32x16_bf16 v[84:99], v[80:83], v[56:59], v[84:99]
    s_cmp_eq_u32 s51, 2
    s_cbranch_scc1 L_2b_done_63
    ds_read_b128 v[64:67], v100 offset:14336
    ds_read_b128 v[76:79], v101 offset:14560
    ds_read_b128 v[80:83], v101 offset:15600
    v_exp_f32 v20, v20
    v_exp_f32 v21, v21
    v_exp_f32 v22, v22
    v_exp_f32 v23, v23
    v_exp_f32 v24, v24
    v_exp_f32 v25, v25
    v_exp_f32 v26, v26
    v_exp_f32 v27, v27
    s_waitcnt lgkmcnt(2)
    v_mfma_f32_32x32x16_bf16 v[36:51], v[64:67], v[160:163], 0
    v_cvt_pk_bf16_f32 v52, v20, v21
    v_cvt_pk_bf16_f32 v53, v22, v23
    v_cvt_pk_bf16_f32 v54, v24, v25
    v_cvt_pk_bf16_f32 v55, v26, v27
    s_nop 1
    v_mfma_f32_32x32x16_bf16 v[84:99], v[68:71], v[52:55], v[84:99]
    v_exp_f32 v28, v28
    v_exp_f32 v29, v29
    v_exp_f32 v30, v30
    v_exp_f32 v31, v31
    v_exp_f32 v32, v32
    v_exp_f32 v33, v33
    v_exp_f32 v34, v34
    v_exp_f32 v35, v35
    v_cvt_pk_bf16_f32 v56, v28, v29
    v_cvt_pk_bf16_f32 v57, v30, v31
    v_cvt_pk_bf16_f32 v58, v32, v33
    v_cvt_pk_bf16_f32 v59, v34, v35
    s_nop 1
    v_mfma_f32_32x32x16_bf16 v[84:99], v[72:75], v[56:59], v[84:99]
    s_cmp_eq_u32 s51, 1
    s_cbranch_scc1 L_2b_done_63
    v_exp_f32 v36, v36
    v_exp_f32 v37, v37
    v_exp_f32 v38, v38
    v_exp_f32 v39, v39
    v_exp_f32 v40, v40
    v_exp_f32 v41, v41
    v_exp_f32 v42, v42
    v_exp_f32 v43, v43
    v_cvt_pk_bf16_f32 v52, v36, v37
    v_cvt_pk_bf16_f32 v53, v38, v39
    v_cvt_pk_bf16_f32 v54, v40, v41
    v_cvt_pk_bf16_f32 v55, v42, v43
    s_waitcnt lgkmcnt(0)
    s_nop 0
    v_mfma_f32_32x32x16_bf16 v[84:99], v[76:79], v[52:55], v[84:99]
    v_exp_f32 v44, v44
    v_exp_f32 v45, v45
    v_exp_f32 v46, v46
    v_exp_f32 v47, v47
    v_exp_f32 v48, v48
    v_exp_f32 v49, v49
    v_exp_f32 v50, v50
    v_exp_f32 v51, v51
    v_cvt_pk_bf16_f32 v56, v44, v45
    v_cvt_pk_bf16_f32 v57, v46, v47
    v_cvt_pk_bf16_f32 v58, v48, v49
    v_cvt_pk_bf16_f32 v59, v50, v51
    s_nop 1
    v_mfma_f32_32x32x16_bf16 v[84:99], v[80:83], v[56:59], v[84:99]
L_2b_done_63:
    s_waitcnt lgkmcnt(0)
    v_mov_b32 v10, 0x21800000
    v_mov_b32 v11, 0x5d800000
    s_lshl_b32 s55, s46, 2
    s_add_u32 s55, s55, s51
    s_lshl_b32 s55, s55, 5
    s_lshl_b32 s61, s47, 1
    s_add_u32 s55, s55, s61
    s_add_u32 s55, s55, s54
    s_lshl_b32 s62, s55, 2
    s_add_u32 s62, s62, 40960
    s_lshl_b32 s55, s51, 2
    s_add_u32 s55, s55, s54
    s_lshl_b32 s55, s55, 10
    s_add_u32 s61, s55, s88
    v_cmp_nlt_f32 vcc, v10, v92
    v_cmp_nlt_f32 s[56:57], v92, v11
    s_or_b64 vcc, vcc, s[56:57]
    s_cbranch_vccnz L_fb_64
L_fbret_65:
    s_nop 7
    v_rcp_f32 v10, v92
    s_nop 0
    v_mul_f32 v84, v84, v10
    v_mul_f32 v85, v85, v10
    v_mul_f32 v86, v86, v10
    v_mul_f32 v87, v87, v10
    v_mul_f32 v88, v88, v10
    v_mul_f32 v89, v89, v10
    v_mul_f32 v90, v90, v10
    v_mul_f32 v91, v91, v10
    v_cvt_pk_bf16_f32 v12, v84, v85
    v_cvt_pk_bf16_f32 v13, v86, v87
    v_cvt_pk_bf16_f32 v14, v88, v89
    v_cvt_pk_bf16_f32 v15, v90, v91
    s_waitcnt vmcnt(0)
    v_cmp_ne_u32 vcc, s52, v103
    s_cbranch_vccnz L_rdx_67
L_rdc_66:
    s_cmp_eq_u32 s53, 1
    s_cbranch_scc0 L_safe_68
    buffer_store_dwordx4 v[12:15], v2, s[28:31], s61 offen
L_back_69:
    v_mov_b32 v102, 0
    ds_read_b32 v10, v102 offset:2836
    s_waitcnt lgkmcnt(0)
    v_cmp_gt_u32 vcc, 4, v10
    s_cbranch_vccnz L_lwx_71
L_lw_70:
    ds_read_b64_tr_b16 v[16:17], v6 offset:0
    ds_read_b64_tr_b16 v[18:19], v6 offset:1024
    ds_read_b64_tr_b16 v[20:21], v7 offset:0
    ds_read_b64_tr_b16 v[22:23], v7 offset:1024
    ds_read_b64_tr_b16 v[24:25], v6 offset:2048
    ds_read_b64_tr_b16 v[26:27], v6 offset:3072
    ds_read_b64_tr_b16 v[28:29], v7 offset:2048
    ds_read_b64_tr_b16 v[30:31], v7 offset:3072
    s_waitcnt lgkmcnt(4)
    ds_read_b64_tr_b16 v[32:33], v6 offset:4096
    ds_read_b64_tr_b16 v[34:35], v6 offset:5120
    ds_read_b64_tr_b16 v[36:37], v7 offset:4096
    ds_read_b64_tr_b16 v[38:39], v7 offset:5120
    ds_read_b64_tr_b16 v[40:41], v6 offset:6144
    ds_read_b64_tr_b16 v[42:43], v6 offset:7168
    ds_read_b64_tr_b16 v[44:45], v7 offset:6144
    ds_read_b64_tr_b16 v[46:47], v7 offset:7168
    s_waitcnt lgkmcnt(4)
    ds_read_b64_tr_b16 v[48:49], v6 offset:8192
    ds_read_b64_tr_b16 v[50:51], v6 offset:9216
    ds_read_b64_tr_b16 v[52:53], v7 offset:8192
    ds_read_b64_tr_b16 v[54:55], v7 offset:9216
    ds_read_b64_tr_b16 v[56:57], v6 offset:10240
    ds_read_b64_tr_b16 v[58:59], v6 offset:11264
    ds_read_b64_tr_b16 v[60:61], v7 offset:10240
    ds_read_b64_tr_b16 v[62:63], v7 offset:11264
    s_waitcnt lgkmcnt(4)
    ds_read_b64_tr_b16 v[64:65], v6 offset:12288
    ds_read_b64_tr_b16 v[66:67], v6 offset:13312
    ds_read_b64_tr_b16 v[68:69], v7 offset:12288
    ds_read_b64_tr_b16 v[70:71], v7 offset:13312
    ds_read_b64_tr_b16 v[72:73], v6 offset:14336
    ds_read_b64_tr_b16 v[74:75], v6 offset:15360
    ds_read_b64_tr_b16 v[76:77], v7 offset:14336
    ds_read_b64_tr_b16 v[78:79], v7 offset:15360
    s_waitcnt lgkmcnt(4)
    v_mov_b32 v10, s62
    v_mov_b32 v11, s52
    s_waitcnt vmcnt(0)
    s_mov_b64 exec, 1
    s_cmp_eq_u32 s53, 1
    s_cbranch_scc0 L_safe_72
    buffer_store_dword v11, v10, s[28:31], 0 offen
L_back_73:
    s_mov_b64 exec, -1
    s_setprio 2
    ds_read_b64_tr_b16 v[80:81], v6 offset:16384
    ds_read_b64_tr_b16 v[82:83], v6 offset:17408
    ds_read_b64_tr_b16 v[84:85], v7 offset:16384
    ds_read_b64_tr_b16 v[86:87], v7 offset:17408
    ds_read_b64_tr_b16 v[88:89], v6 offset:18432
    ds_read_b64_tr_b16 v[90:91], v6 offset:19456
    ds_read_b64_tr_b16 v[92:93], v7 offset:18432
    ds_read_b64_tr_b16 v[94:95], v7 offset:19456
    s_waitcnt lgkmcnt(4)
    ds_read_b64_tr_b16 v[96:97], v6 offset:20480
    ds_read_b64_tr_b16 v[98:99], v6 offset:21504
    ds_read_b64_tr_b16 v[100:101], v7 offset:20480
    ds_read_b64_tr_b16 v[102:103], v7 offset:21504
    ds_read_b64_tr_b16 v[104:105], v6 offset:22528
    ds_read_b64_tr_b16 v[106:107], v6 offset:23552
    ds_read_b64_tr_b16 v[108:109], v7 offset:22528
    ds_read_b64_tr_b16 v[110:111], v7 offset:23552
    s_waitcnt lgkmcnt(4)
    ds_read_b64_tr_b16 v[112:113], v6 offset:24576
    ds_read_b64_tr_b16 v[114:115], v6 offset:25600
    ds_read_b64_tr_b16 v[116:117], v7 offset:24576
    ds_read_b64_tr_b16 v[118:119], v7 offset:25600
    ds_read_b64_tr_b16 v[120:121], v6 offset:26624
    ds_read_b64_tr_b16 v[122:123], v6 offset:27648
    ds_read_b64_tr_b16 v[124:125], v7 offset:26624
    ds_read_b64_tr_b16 v[126:127], v7 offset:27648
    s_waitcnt lgkmcnt(4)
    ds_read_b64_tr_b16 v[128:129], v6 offset:28672
    ds_read_b64_tr_b16 v[130:131], v6 offset:29696
    ds_read_b64_tr_b16 v[132:133], v7 offset:28672
    ds_read_b64_tr_b16 v[134:135], v7 offset:29696
    ds_read_b64_tr_b16 v[136:137], v6 offset:30720
    ds_read_b64_tr_b16 v[138:139], v6 offset:31744
    ds_read_b64_tr_b16 v[140:141], v7 offset:30720
    ds_read_b64_tr_b16 v[142:143], v7 offset:31744
    s_waitcnt lgkmcnt(4)
    v_and_b32 v8, 15, v1
    v_lshlrev_b32 v8, 2, v8
    s_lshl_b32 s55, s64, 1
    s_add_u32 s55, s55, s95
    s_lshl_b32 s56, s46, 18
    s_lshl_b32 s57, s95, 17
    s_add_u32 s56, s56, s57
    s_and_b32 s57, s64, 3
    s_lshl_b32 s57, s57, 12
    s_add_u32 s56, s56, s57
    s_lshl_b32 s55, s55, 6
    s_add_u32 s55, s55, 40960
    v_add_u32 v10, s55, v8
    v_lshlrev_b32 v208, 16, v240
    v_and_b32 v209, 0xffff0000, v240
    v_lshlrev_b32 v210, 16, v241
    v_and_b32 v211, 0xffff0000, v241
    v_lshlrev_b32 v212, 16, v242
    v_and_b32 v213, 0xffff0000, v242
    v_lshlrev_b32 v214, 16, v243
    v_and_b32 v215, 0xffff0000, v243
    v_lshlrev_b32 v216, 16, v244
    v_and_b32 v217, 0xffff0000, v244
    v_lshlrev_b32 v218, 16, v245
    v_and_b32 v219, 0xffff0000, v245
    v_lshlrev_b32 v220, 16, v246
    v_and_b32 v221, 0xffff0000, v246
    v_lshlrev_b32 v222, 16, v247
    v_and_b32 v223, 0xffff0000, v247
    s_waitcnt lgkmcnt(0)
    s_barrier
    s_mov_b32 s55, 0
L_poll_74:
    buffer_load_dword v11, v10, s[28:31], 0 offen sc1
    s_waitcnt vmcnt(0)
    v_cmp_ne_u32 vcc, s52, v11
    s_cbranch_vccnz L_pollx_76
L_polld_75:
    s_add_u32 s57, s56, 1048576
    buffer_load_dwordx4 v[144:147], v2, s[28:31], s57 offen offset:0 sc1
    buffer_load_dwordx4 v[148:151], v2, s[28:31], s57 offen offset:1024 sc1
    s_add_u32 s57, s56, 1064960
    buffer_load_dwordx4 v[152:155], v2, s[28:31], s57 offen offset:0 sc1
    buffer_load_dwordx4 v[156:159], v2, s[28:31], s57 offen offset:1024 sc1
    s_add_u32 s57, s56, 1081344
    buffer_load_dwordx4 v[160:163], v2, s[28:31], s57 offen offset:0 sc1
    buffer_load_dwordx4 v[164:167], v2, s[28:31], s57 offen offset:1024 sc1
    s_add_u32 s57, s56, 1097728
    buffer_load_dwordx4 v[168:171], v2, s[28:31], s57 offen offset:0 sc1
    buffer_load_dwordx4 v[172:175], v2, s[28:31], s57 offen offset:1024 sc1
    s_lshl_b32 s55, s50, 12
    s_add_u32 s55, s55, 118784
    v_add_u32 v10, s55, v2
    s_xor_b32 s55, s50, 2
    s_lshl_b32 s55, s55, 12
    s_add_u32 s55, s55, 118784
    v_add_u32 v11, s55, v2
    v_mov_b32 v12, 0
    v_mov_b32 v13, 1
    s_lshl_b32 s55, s94, 2
    v_mov_b32 v14, s55
    s_waitcnt vmcnt(7)
    v_mfma_f32_32x32x16_bf16 v[224:239], v[20:23], v[144:147], 0
    s_add_u32 s57, s56, 1114112
    buffer_load_dwordx4 v[176:179], v2, s[28:31], s57 offen offset:0 sc1
    v_mfma_f32_32x32x16_bf16 v[208:223], v[16:19], v[144:147], v[208:223]
    buffer_load_dwordx4 v[180:183], v2, s[28:31], s57 offen offset:1024 sc1
    s_waitcnt vmcnt(8)
    v_mfma_f32_32x32x16_bf16 v[224:239], v[28:31], v[148:151], v[224:239]
    s_add_u32 s57, s56, 1130496
    buffer_load_dwordx4 v[184:187], v2, s[28:31], s57 offen offset:0 sc1
    v_mfma_f32_32x32x16_bf16 v[208:223], v[24:27], v[148:151], v[208:223]
    buffer_load_dwordx4 v[188:191], v2, s[28:31], s57 offen offset:1024 sc1
    s_waitcnt vmcnt(9)
    v_mfma_f32_32x32x16_bf16 v[224:239], v[36:39], v[152:155], v[224:239]
    s_add_u32 s57, s56, 1146880
    buffer_load_dwordx4 v[192:195], v2, s[28:31], s57 offen offset:0 sc1
    v_mfma_f32_32x32x16_bf16 v[208:223], v[32:35], v[152:155], v[208:223]
    buffer_load_dwordx4 v[196:199], v2, s[28:31], s57 offen offset:1024 sc1
    s_waitcnt vmcnt(10)
    v_mfma_f32_32x32x16_bf16 v[224:239], v[44:47], v[156:159], v[224:239]
    s_add_u32 s57, s56, 1163264
    buffer_load_dwordx4 v[200:203], v2, s[28:31], s57 offen offset:0 sc1
    v_mfma_f32_32x32x16_bf16 v[208:223], v[40:43], v[156:159], v[208:223]
    buffer_load_dwordx4 v[204:207], v2, s[28:31], s57 offen offset:1024 sc1
    s_mov_b64 exec, 1
    ds_add_u32 v12, v13 offset:2840
    s_mov_b64 exec, -1
    s_waitcnt vmcnt(11)
    v_mfma_f32_32x32x16_bf16 v[224:239], v[52:55], v[160:163], v[224:239]
    v_mfma_f32_32x32x16_bf16 v[208:223], v[48:51], v[160:163], v[208:223]
    s_waitcnt vmcnt(10)
    v_mfma_f32_32x32x16_bf16 v[224:239], v[60:63], v[164:167], v[224:239]
    v_mfma_f32_32x32x16_bf16 v[208:223], v[56:59], v[164:167], v[208:223]
    s_waitcnt vmcnt(9)
    v_mfma_f32_32x32x16_bf16 v[224:239], v[68:71], v[168:171], v[224:239]
    v_mfma_f32_32x32x16_bf16 v[208:223], v[64:67], v[168:171], v[208:223]
    s_waitcnt vmcnt(8)
    v_mfma_f32_32x32x16_bf16 v[224:239], v[76:79], v[172:175], v[224:239]
    v_mfma_f32_32x32x16_bf16 v[208:223], v[72:75], v[172:175], v[208:223]
    s_waitcnt vmcnt(7)
    v_mfma_f32_32x32x16_bf16 v[224:239], v[84:87], v[176:179], v[224:239]
    v_mfma_f32_32x32x16_bf16 v[208:223], v[80:83], v[176:179], v[208:223]
    s_waitcnt vmcnt(6)
    v_mfma_f32_32x32x16_bf16 v[224:239], v[92:95], v[180:183], v[224:239]
    v_mfma_f32_32x32x16_bf16 v[208:223], v[88:91], v[180:183], v[208:223]
    s_waitcnt vmcnt(5)
    v_mfma_f32_32x32x16_bf16 v[224:239], v[100:103], v[184:187], v[224:239]
    v_mfma_f32_32x32x16_bf16 v[208:223], v[96:99], v[184:187], v[208:223]
    s_waitcnt vmcnt(4)
    v_mfma_f32_32x32x16_bf16 v[224:239], v[108:111], v[188:191], v[224:239]
    s_waitcnt vmcnt(3)
    v_mfma_f32_32x32x16_bf16 v[224:239], v[116:119], v[192:195], v[224:239]
    s_waitcnt vmcnt(2)
    v_mfma_f32_32x32x16_bf16 v[224:239], v[124:127], v[196:199], v[224:239]
    s_waitcnt vmcnt(1)
    v_mfma_f32_32x32x16_bf16 v[224:239], v[132:135], v[200:203], v[224:239]
    s_waitcnt vmcnt(0)
    v_mfma_f32_32x32x16_bf16 v[224:239], v[140:143], v[204:207], v[224:239]
    v_mfma_f32_32x32x16_bf16 v[208:223], v[104:107], v[188:191], v[208:223]
    v_mfma_f32_32x32x16_bf16 v[208:223], v[112:115], v[192:195], v[208:223]
    s_nop 9
    ds_write_b128 v10, v[224:227] offset:0
    v_mfma_f32_32x32x16_bf16 v[208:223], v[120:123], v[196:199], v[208:223]
    ds_write_b128 v10, v[228:231] offset:1024
    v_mfma_f32_32x32x16_bf16 v[208:223], v[128:131], v[200:203], v[208:223]
    ds_write_b128 v10, v[232:235] offset:2048
    v_mfma_f32_32x32x16_bf16 v[208:223], v[136:139], v[204:207], v[208:223]
    ds_write_b128 v10, v[236:239] offset:3072
    s_mov_b64 exec, 1
    ds_add_u32 v14, v13 offset:2872
    s_mov_b64 exec, -1
    ds_read_b32 v15, v14 offset:2872
    s_waitcnt lgkmcnt(0)
    v_cmp_gt_u32 vcc, 2, v15
    s_cbranch_vccnz L_lwx_78
L_lw_77:
    ds_read_b128 v[16:19], v11 offset:0
    ds_read_b128 v[20:23], v11 offset:1024
    ds_read_b128 v[24:27], v11 offset:2048
    ds_read_b128 v[28:31], v11 offset:3072
    s_waitcnt lgkmcnt(3)
    v_add_f32 v16, v16, v208
    v_add_f32 v17, v17, v209
    v_add_f32 v18, v18, v210
    v_add_f32 v19, v19, v211
    s_waitcnt lgkmcnt(2)
    v_add_f32 v20, v20, v212
    v_add_f32 v21, v21, v213
    v_add_f32 v22, v22, v214
    v_add_f32 v23, v23, v215
    s_waitcnt lgkmcnt(1)
    v_add_f32 v24, v24, v216
    v_add_f32 v25, v25, v217
    v_add_f32 v26, v26, v218
    v_add_f32 v27, v27, v219
    s_waitcnt lgkmcnt(0)
    v_add_f32 v28, v28, v220
    v_add_f32 v29, v29, v221
    v_add_f32 v30, v30, v222
    v_add_f32 v31, v31, v223
    v_cvt_pk_bf16_f32 v248, v16, v17
    v_cvt_pk_bf16_f32 v249, v18, v19
    v_cvt_pk_bf16_f32 v250, v20, v21
    v_cvt_pk_bf16_f32 v251, v22, v23
    v_cvt_pk_bf16_f32 v252, v24, v25
    v_cvt_pk_bf16_f32 v253, v26, v27
    v_cvt_pk_bf16_f32 v254, v28, v29
    v_cvt_pk_bf16_f32 v255, v30, v31
    s_lshl_b32 s55, s49, 1
    s_add_u32 s55, s55, s95
    s_lshl_b32 s58, s64, 4
    s_add_u32 s58, s58, s55
    s_add_u32 s56, s60, 2048
    s_cmp_eq_u32 s53, 1
    s_cbranch_scc0 L_safe_79
    buffer_store_dwordx4 v[248:251], v2, s[28:31], s56 offen
    buffer_store_dwordx4 v[252:255], v2, s[28:31], s56 offen offset:1024
L_back_80:
    v_mov_b32 v18, 0x3f803f80
    v_mov_b32 v12, 0
    v_mov_b32 v13, 0
    v_dot2c_f32_bf16 v12, v248, v18
    v_dot2c_f32_bf16 v13, v248, v248
    v_dot2c_f32_bf16 v12, v249, v18
    v_dot2c_f32_bf16 v13, v249, v249
    v_dot2c_f32_bf16 v12, v250, v18
    v_dot2c_f32_bf16 v13, v250, v250
    v_dot2c_f32_bf16 v12, v251, v18
    v_dot2c_f32_bf16 v13, v251, v251
    v_dot2c_f32_bf16 v12, v252, v18
    v_dot2c_f32_bf16 v13, v252, v252
    v_dot2c_f32_bf16 v12, v253, v18
    v_dot2c_f32_bf16 v13, v253, v253
    v_dot2c_f32_bf16 v12, v254, v18
    v_dot2c_f32_bf16 v13, v254, v254
    v_dot2c_f32_bf16 v12, v255, v18
    v_dot2c_f32_bf16 v13, v255, v255
    s_lshl_b32 s57, s58, 8
    s_add_u32 s57, s57, 10485760
    s_lshl_b32 s58, s64, 5
    s_add_u32 s58, s58, s55
    s_lshl_b32 s58, s58, 2
    s_add_u32 s58, s58, 49152
    v_and_b32 v14, 31, v1
    v_lshlrev_b32 v14, 3, v14
    v_mov_b32 v10, v12
    s_nop 1
    v_permlane32_swap_b32 v12, v10
    v_add_f32 v12, v12, v10
    v_mov_b32 v10, v13
    s_nop 1
    v_permlane32_swap_b32 v13, v10
    v_add_f32 v13, v13, v10
    s_cmp_eq_u32 s53, 1
    s_cbranch_scc0 L_safe_81
    buffer_store_dwordx2 v[12:13], v14, s[28:31], s57 offen
L_back_82:
    v_mov_b32 v246, 0
    v_mov_b32 v247, 1
    ds_read_b32 v10, v246 offset:2868
    s_waitcnt lgkmcnt(0)
    v_cmp_gt_u32 vcc, 4, v10
    s_cbranch_vccnz L_lwx_84
L_lw_83:
    v_bfe_u32 v10, v1, 2, 2
    v_lshrrev_b32 v11, 5, v1
    v_lshl_add_u32 v10, v11, 2, v10
    v_mul_u32_u24 v10, 192, v10
    v_bfe_u32 v11, v1, 4, 1
    v_lshl_add_u32 v10, v11, 5, v10
    v_and_b32 v11, 3, v1
    v_lshl_add_u32 v3, v11, 3, v10
    v_add_u32 v6, 0x10000, v3
    ds_read_b64_tr_b16 v[192:193], v3 offset:3072
    ds_read_b64_tr_b16 v[194:195], v3 offset:4608
    ds_read_b64_tr_b16 v[196:197], v3 offset:3136
    ds_read_b64_tr_b16 v[198:199], v3 offset:4672
    ds_read_b64_tr_b16 v[200:201], v3 offset:3200
    ds_read_b64_tr_b16 v[202:203], v3 offset:4736
    ds_read_b64_tr_b16 v[204:205], v3 offset:6144
    ds_read_b64_tr_b16 v[206:207], v3 offset:7680
    ds_read_b64_tr_b16 v[208:209], v3 offset:6208
    ds_read_b64_tr_b16 v[210:211], v3 offset:7744
    ds_read_b64_tr_b16 v[212:213], v3 offset:6272
    ds_read_b64_tr_b16 v[214:215], v3 offset:7808
    v_mov_b32 v10, s58
    v_mov_b32 v11, s52
    s_waitcnt vmcnt(0)
    s_mov_b64 exec, 1
    s_cmp_eq_u32 s53, 1
    s_cbranch_scc0 L_safe_85
    buffer_store_dword v11, v10, s[28:31], 0 offen
L_back_86:
    s_mov_b64 exec, -1
    s_lshl_b32 s55, s46, 2
    s_add_u32 s62, s55, s50
    s_lshl_b32 s56, s46, 18
    s_lshl_b32 s57, s95, 17
    s_add_u32 s56, s56, s57
    s_lshl_b32 s57, s94, 12
    s_add_u32 s56, s56, s57
    s_lshl_b32 s55, s62, 7
    s_add_u32 s55, s55, 49152
    v_add_u32 v10, s55, v8
    s_mov_b32 s55, 0
L_poll_87:
    buffer_load_dword v11, v10, s[28:31], 0 offen sc1
    s_waitcnt vmcnt(0)
    v_cmp_ne_u32 vcc, s52, v11
    s_cbranch_vccnz L_pollx_89
L_polld_88:
    s_add_u32 s57, s56, 1048576
    buffer_load_dwordx4 v[16:19], v2, s[28:31], s57 offen offset:2048 sc1
    buffer_load_dwordx4 v[20:23], v2, s[28:31], s57 offen offset:3072 sc1
    s_add_u32 s57, s56, 1056768
    buffer_load_dwordx4 v[24:27], v2, s[28:31], s57 offen offset:2048 sc1
    buffer_load_dwordx4 v[28:31], v2, s[28:31], s57 offen offset:3072 sc1
    s_add_u32 s57, s56, 1064960
    buffer_load_dwordx4 v[32:35], v2, s[28:31], s57 offen offset:2048 sc1
    buffer_load_dwordx4 v[36:39], v2, s[28:31], s57 offen offset:3072 sc1
    v_lshrrev_b32 v13, 1, v14
    s_lshl_b32 s55, s50, 7
    v_add_u32 v13, s55, v13
    v_lshrrev_b32 v12, 5, v1
    v_lshlrev_b32 v12, 4, v12
    s_lshl_b32 s59, s62, 4
    s_add_u32 s59, s59, s47
    s_lshl_b32 s59, s59, 12
    s_add_u32 s59, s59, 6291456
    s_lshl_b32 s58, s62, 5
    s_add_u32 s58, s58, s47
    s_lshl_b32 s58, s58, 2
    s_add_u32 s58, s58, 57344
    s_waitcnt vmcnt(5)
    s_waitcnt lgkmcnt(6)
    v_mfma_f32_32x32x16_bf16 v[144:159], v[192:195], v[16:19], 0
    ds_read_b64_tr_b16 v[216:217], v3 offset:9216
    ds_read_b64_tr_b16 v[218:219], v3 offset:10752
    v_mfma_f32_32x32x16_bf16 v[160:175], v[196:199], v[16:19], 0
    ds_read_b64_tr_b16 v[220:221], v3 offset:9280
    ds_read_b64_tr_b16 v[222:223], v3 offset:10816
    s_add_u32 s57, s56, 1073152
    buffer_load_dwordx4 v[40:43], v2, s[28:31], s57 offen offset:2048 sc1
    v_mfma_f32_32x32x16_bf16 v[176:191], v[200:203], v[16:19], 0
    ds_read_b64_tr_b16 v[224:225], v3 offset:9344
    ds_read_b64_tr_b16 v[226:227], v3 offset:10880
    s_waitcnt vmcnt(5)
    s_waitcnt lgkmcnt(6)
    v_mfma_f32_32x32x16_bf16 v[144:159], v[204:207], v[20:23], v[144:159]
    ds_read_b64_tr_b16 v[192:193], v3 offset:12288
    ds_read_b64_tr_b16 v[194:195], v3 offset:13824
    buffer_load_dwordx4 v[44:47], v2, s[28:31], s57 offen offset:3072 sc1
    v_mfma_f32_32x32x16_bf16 v[160:175], v[208:211], v[20:23], v[160:175]
    ds_read_b64_tr_b16 v[196:197], v3 offset:12352
    ds_read_b64_tr_b16 v[198:199], v3 offset:13888
    v_mfma_f32_32x32x16_bf16 v[176:191], v[212:215], v[20:23], v[176:191]
    ds_read_b64_tr_b16 v[200:201], v3 offset:12416
    ds_read_b64_tr_b16 v[202:203], v3 offset:13952
    s_add_u32 s57, s56, 1081344
    buffer_load_dwordx4 v[48:51], v2, s[28:31], s57 offen offset:2048 sc1
    s_waitcnt vmcnt(6)
    s_waitcnt lgkmcnt(10)
    v_mfma_f32_32x32x16_bf16 v[144:159], v[216:219], v[24:27], v[144:159]
    ds_read_b64_tr_b16 v[204:205], v3 offset:15360
    ds_read_b64_tr_b16 v[206:207], v3 offset:16896
    s_waitcnt lgkmcnt(10)
    v_mfma_f32_32x32x16_bf16 v[160:175], v[220:223], v[24:27], v[160:175]
    ds_read_b64_tr_b16 v[208:209], v3 offset:15424
    ds_read_b64_tr_b16 v[210:211], v3 offset:16960
    buffer_load_dwordx4 v[52:55], v2, s[28:31], s57 offen offset:3072 sc1
    s_waitcnt lgkmcnt(10)
    v_mfma_f32_32x32x16_bf16 v[176:191], v[224:227], v[24:27], v[176:191]
    ds_read_b64_tr_b16 v[212:213], v3 offset:15488
    ds_read_b64_tr_b16 v[214:215], v3 offset:17024
    s_waitcnt vmcnt(6)
    s_waitcnt lgkmcnt(10)
    v_mfma_f32_32x32x16_bf16 v[144:159], v[192:195], v[28:31], v[144:159]
    ds_read_b64_tr_b16 v[216:217], v3 offset:18432
    ds_read_b64_tr_b16 v[218:219], v3 offset:19968
    s_add_u32 s57, s56, 1089536
    buffer_load_dwordx4 v[56:59], v2, s[28:31], s57 offen offset:2048 sc1
    s_waitcnt lgkmcnt(10)
    v_mfma_f32_32x32x16_bf16 v[160:175], v[196:199], v[28:31], v[160:175]
    ds_read_b64_tr_b16 v[220:221], v3 offset:18496
    ds_read_b64_tr_b16 v[222:223], v3 offset:20032
    s_waitcnt lgkmcnt(10)
    v_mfma_f32_32x32x16_bf16 v[176:191], v[200:203], v[28:31], v[176:191]
    ds_read_b64_tr_b16 v[224:225], v3 offset:18560
    ds_read_b64_tr_b16 v[226:227], v3 offset:20096
    buffer_load_dwordx4 v[60:63], v2, s[28:31], s57 offen offset:3072 sc1
    s_waitcnt vmcnt(7)
    s_waitcnt lgkmcnt(10)
    v_mfma_f32_32x32x16_bf16 v[144:159], v[204:207], v[32:35], v[144:159]
    ds_read_b64_tr_b16 v[192:193], v3 offset:21504
    ds_read_b64_tr_b16 v[194:195], v3 offset:23040
    s_waitcnt lgkmcnt(10)
    v_mfma_f32_32x32x16_bf16 v[160:175], v[208:211], v[32:35], v[160:175]
    ds_read_b64_tr_b16 v[196:197], v3 offset:21568
    ds_read_b64_tr_b16 v[198:199], v3 offset:23104
    s_add_u32 s57, s56, 1097728
    buffer_load_dwordx4 v[64:67], v2, s[28:31], s57 offen offset:2048 sc1
    s_waitcnt lgkmcnt(10)
    v_mfma_f32_32x32x16_bf16 v[176:191], v[212:215], v[32:35], v[176:191]
    ds_read_b64_tr_b16 v[200:201], v3 offset:21632
    ds_read_b64_tr_b16 v[202:203], v3 offset:23168
    s_waitcnt vmcnt(7)
    s_waitcnt lgkmcnt(10)
    v_mfma_f32_32x32x16_bf16 v[144:159], v[216:219], v[36:39], v[144:159]
    ds_read_b64_tr_b16 v[204:205], v3 offset:24576
    ds_read_b64_tr_b16 v[206:207], v3 offset:26112
    buffer_load_dwordx4 v[68:71], v2, s[28:31], s57 offen offset:3072 sc1
    s_waitcnt lgkmcnt(10)
    v_mfma_f32_32x32x16_bf16 v[160:175], v[220:223], v[36:39], v[160:175]
    ds_read_b64_tr_b16 v[208:209], v3 offset:24640
    ds_read_b64_tr_b16 v[210:211], v3 offset:26176
    s_waitcnt lgkmcnt(10)
    v_mfma_f32_32x32x16_bf16 v[176:191], v[224:227], v[36:39], v[176:191]
    ds_read_b64_tr_b16 v[212:213], v3 offset:24704
    ds_read_b64_tr_b16 v[214:215], v3 offset:26240
    s_add_u32 s57, s56, 1105920
    buffer_load_dwordx4 v[72:75], v2, s[28:31], s57 offen offset:2048 sc1
    s_waitcnt vmcnt(8)
    s_waitcnt lgkmcnt(10)
    v_mfma_f32_32x32x16_bf16 v[144:159], v[192:195], v[40:43], v[144:159]
    ds_read_b64_tr_b16 v[216:217], v3 offset:27648
    ds_read_b64_tr_b16 v[218:219], v3 offset:29184
    s_waitcnt lgkmcnt(10)
    v_mfma_f32_32x32x16_bf16 v[160:175], v[196:199], v[40:43], v[160:175]
    ds_read_b64_tr_b16 v[220:221], v3 offset:27712
    ds_read_b64_tr_b16 v[222:223], v3 offset:29248
    buffer_load_dwordx4 v[76:79], v2, s[28:31], s57 offen offset:3072 sc1
    s_waitcnt lgkmcnt(10)
    v_mfma_f32_32x32x16_bf16 v[176:191], v[200:203], v[40:43], v[176:191]
    ds_read_b64_tr_b16 v[224:225], v3 offset:27776
    ds_read_b64_tr_b16 v[226:227], v3 offset:29312
    s_waitcnt vmcnt(8)
    s_waitcnt lgkmcnt(10)
    v_mfma_f32_32x32x16_bf16 v[144:159], v[204:207], v[44:47], v[144:159]
    ds_read_b64_tr_b16 v[192:193], v3 offset:30720
    ds_read_b64_tr_b16 v[194:195], v3 offset:32256
    s_add_u32 s57, s56, 1114112
    buffer_load_dwordx4 v[80:83], v2, s[28:31], s57 offen offset:2048 sc1
    s_waitcnt lgkmcnt(10)
    v_mfma_f32_32x32x16_bf16 v[160:175], v[208:211], v[44:47], v[160:175]
    ds_read_b64_tr_b16 v[196:197], v3 offset:30784
    ds_read_b64_tr_b16 v[198:199], v3 offset:32320
    s_waitcnt lgkmcnt(10)
    v_mfma_f32_32x32x16_bf16 v[176:191], v[212:215], v[44:47], v[176:191]
    ds_read_b64_tr_b16 v[200:201], v3 offset:30848
    ds_read_b64_tr_b16 v[202:203], v3 offset:32384
    buffer_load_dwordx4 v[84:87], v2, s[28:31], s57 offen offset:3072 sc1
    s_waitcnt vmcnt(9)
    s_waitcnt lgkmcnt(10)
    v_mfma_f32_32x32x16_bf16 v[144:159], v[216:219], v[48:51], v[144:159]
    ds_read_b64_tr_b16 v[204:205], v3 offset:33792
    ds_read_b64_tr_b16 v[206:207], v3 offset:35328
    s_waitcnt lgkmcnt(10)
    v_mfma_f32_32x32x16_bf16 v[160:175], v[220:223], v[48:51], v[160:175]
    ds_read_b64_tr_b16 v[208:209], v3 offset:33856
    ds_read_b64_tr_b16 v[210:211], v3 offset:35392
    s_add_u32 s57, s56, 1122304
    buffer_load_dwordx4 v[88:91], v2, s[28:31], s57 offen offset:2048 sc1
    s_waitcnt lgkmcnt(10)
    v_mfma_f32_32x32x16_bf16 v[176:191], v[224:227], v[48:51], v[176:191]
    ds_read_b64_tr_b16 v[212:213], v3 offset:33920
    ds_read_b64_tr_b16 v[214:215], v3 offset:35456
    s_waitcnt vmcnt(9)
    s_waitcnt lgkmcnt(10)
    v_mfma_f32_32x32x16_bf16 v[144:159], v[192:195], v[52:55], v[144:159]
    ds_read_b64_tr_b16 v[216:217], v3 offset:36864
    ds_read_b64_tr_b16 v[218:219], v3 offset:38400
    buffer_load_dwordx4 v[92:95], v2, s[28:31], s57 offen offset:3072 sc1
    s_waitcnt lgkmcnt(10)
    v_mfma_f32_32x32x16_bf16 v[160:175], v[196:199], v[52:55], v[160:175]
    ds_read_b64_tr_b16 v[220:221], v3 offset:36928
    ds_read_b64_tr_b16 v[222:223], v3 offset:38464
    s_waitcnt lgkmcnt(10)
    v_mfma_f32_32x32x16_bf16 v[176:191], v[200:203], v[52:55], v[176:191]
    ds_read_b64_tr_b16 v[224:225], v3 offset:36992
    ds_read_b64_tr_b16 v[226:227], v3 offset:38528
    s_add_u32 s57, s56, 1130496
    buffer_load_dwordx4 v[96:99], v2, s[28:31], s57 offen offset:2048 sc1
    s_waitcnt vmcnt(10)
    s_waitcnt lgkmcnt(10)
    v_mfma_f32_32x32x16_bf16 v[144:159], v[204:207], v[56:59], v[144:159]
    ds_read_b64_tr_b16 v[192:193], v3 offset:39936
    ds_read_b64_tr_b16 v[194:195], v3 offset:41472
    s_waitcnt lgkmcnt(10)
    v_mfma_f32_32x32x16_bf16 v[160:175], v[208:211], v[56:59], v[160:175]
    ds_read_b64_tr_b16 v[196:197], v3 offset:40000
    ds_read_b64_tr_b16 v[198:199], v3 offset:41536
    buffer_load_dwordx4 v[100:103], v2, s[28:31], s57 offen offset:3072 sc1
    s_waitcnt lgkmcnt(10)
    v_mfma_f32_32x32x16_bf16 v[176:191], v[212:215], v[56:59], v[176:191]
    ds_read_b64_tr_b16 v[200:201], v3 offset:40064
    ds_read_b64_tr_b16 v[202:203], v3 offset:41600
    s_waitcnt vmcnt(10)
    s_waitcnt lgkmcnt(10)
    v_mfma_f32_32x32x16_bf16 v[144:159], v[216:219], v[60:63], v[144:159]
    ds_read_b64_tr_b16 v[204:205], v3 offset:43008
    ds_read_b64_tr_b16 v[206:207], v3 offset:44544
    s_add_u32 s57, s56, 1138688
    buffer_load_dwordx4 v[104:107], v2, s[28:31], s57 offen offset:2048 sc1
    s_waitcnt lgkmcnt(10)
    v_mfma_f32_32x32x16_bf16 v[160:175], v[220:223], v[60:63], v[160:175]
    ds_read_b64_tr_b16 v[208:209], v3 offset:43072
    ds_read_b64_tr_b16 v[210:211], v3 offset:44608
    s_waitcnt lgkmcnt(10)
    v_mfma_f32_32x32x16_bf16 v[176:191], v[224:227], v[60:63], v[176:191]
    ds_read_b64_tr_b16 v[212:213], v3 offset:43136
    ds_read_b64_tr_b16 v[214:215], v3 offset:44672
    buffer_load_dwordx4 v[108:111], v2, s[28:31], s57 offen offset:3072 sc1
    s_waitcnt vmcnt(11)
    s_waitcnt lgkmcnt(10)
    v_mfma_f32_32x32x16_bf16 v[144:159], v[192:195], v[64:67], v[144:159]
    ds_read_b64_tr_b16 v[216:217], v3 offset:46080
    ds_read_b64_tr_b16 v[218:219], v3 offset:47616
    s_waitcnt lgkmcnt(10)
    v_mfma_f32_32x32x16_bf16 v[160:175], v[196:199], v[64:67], v[160:175]
    ds_read_b64_tr_b16 v[220:221], v3 offset:46144
    ds_read_b64_tr_b16 v[222:223], v3 offset:47680
    s_add_u32 s57, s56, 1146880
    buffer_load_dwordx4 v[112:115], v2, s[28:31], s57 offen offset:2048 sc1
    s_waitcnt lgkmcnt(10)
    v_mfma_f32_32x32x16_bf16 v[176:191], v[200:203], v[64:67], v[176:191]
    ds_read_b64_tr_b16 v[224:225], v3 offset:46208
    ds_read_b64_tr_b16 v[226:227], v3 offset:47744
    s_waitcnt vmcnt(11)
    s_waitcnt lgkmcnt(10)
    v_mfma_f32_32x32x16_bf16 v[144:159], v[204:207], v[68:71], v[144:159]
    ds_read_b64_tr_b16 v[192:193], v3 offset:49152
    ds_read_b64_tr_b16 v[194:195], v3 offset:50688
    buffer_load_dwordx4 v[116:119], v2, s[28:31], s57 offen offset:3072 sc1
    s_waitcnt lgkmcnt(10)
    v_mfma_f32_32x32x16_bf16 v[160:175], v[208:211], v[68:71], v[160:175]
    ds_read_b64_tr_b16 v[196:197], v3 offset:49216
    ds_read_b64_tr_b16 v[198:199], v3 offset:50752
    s_waitcnt lgkmcnt(10)
    v_mfma_f32_32x32x16_bf16 v[176:191], v[212:215], v[68:71], v[176:191]
    ds_read_b64_tr_b16 v[200:201], v3 offset:49280
    ds_read_b64_tr_b16 v[202:203], v3 offset:50816
    s_add_u32 s57, s56, 1155072
    buffer_load_dwordx4 v[120:123], v2, s[28:31], s57 offen offset:2048 sc1
    s_waitcnt vmcnt(12)
    s_waitcnt lgkmcnt(10)
    v_mfma_f32_32x32x16_bf16 v[144:159], v[216:219], v[72:75], v[144:159]
    ds_read_b64_tr_b16 v[204:205], v3 offset:52224
    ds_read_b64_tr_b16 v[206:207], v3 offset:53760
    ds_read_b32 v10, v246 offset:2824
    s_waitcnt lgkmcnt(11)
    v_mfma_f32_32x32x16_bf16 v[160:175], v[220:223], v[72:75], v[160:175]
    ds_read_b64_tr_b16 v[208:209], v3 offset:55296
    ds_read_b64_tr_b16 v[210:211], v3 offset:56832
    buffer_load_dwordx4 v[124:127], v2, s[28:31], s57 offen offset:3072 sc1
    s_waitcnt lgkmcnt(11)
    v_mfma_f32_32x32x16_bf16 v[176:191], v[224:227], v[72:75], v[176:191]
    ds_read_b64_tr_b16 v[212:213], v3 offset:58368
    ds_read_b64_tr_b16 v[214:215], v3 offset:59904
    s_waitcnt vmcnt(12)
    s_waitcnt lgkmcnt(11)
    v_mfma_f32_32x32x16_bf16 v[144:159], v[192:195], v[76:79], v[144:159]
    ds_read_b64_tr_b16 v[216:217], v3 offset:61440
    ds_read_b64_tr_b16 v[218:219], v3 offset:62976
    s_add_u32 s57, s56, 1163264
    buffer_load_dwordx4 v[128:131], v2, s[28:31], s57 offen offset:2048 sc1
    s_waitcnt lgkmcnt(11)
    v_mfma_f32_32x32x16_bf16 v[160:175], v[196:199], v[76:79], v[160:175]
    ds_read_b64_tr_b16 v[220:221], v3 offset:64512
    ds_read_b64_tr_b16 v[222:223], v6 offset:512
    s_waitcnt lgkmcnt(11)
    v_mfma_f32_32x32x16_bf16 v[176:191], v[200:203], v[76:79], v[176:191]
    ds_read_b64_tr_b16 v[224:225], v6 offset:2048
    ds_read_b64_tr_b16 v[226:227], v6 offset:3584
    buffer_load_dwordx4 v[132:135], v2, s[28:31], s57 offen offset:3072 sc1
    s_waitcnt vmcnt(13)
    s_waitcnt lgkmcnt(11)
    v_mfma_f32_32x32x16_bf16 v[144:159], v[204:207], v[80:83], v[144:159]
    ds_read_b64_tr_b16 v[192:193], v6 offset:5120
    ds_read_b64_tr_b16 v[194:195], v6 offset:6656
    s_waitcnt lgkmcnt(12)
    v_cmp_gt_u32 vcc, 4, v10
    s_cbranch_vccnz L_lwx_91
L_lw_90:
    ds_read_b32 v244, v13 offset:0
    ds_read_b32 v245, v13 offset:512
    s_waitcnt vmcnt(12)
    s_waitcnt lgkmcnt(12)
    v_mfma_f32_32x32x16_bf16 v[144:159], v[208:211], v[84:87], v[144:159]
    ds_read_b64_tr_b16 v[196:197], v6 offset:8192
    ds_read_b64_tr_b16 v[198:199], v6 offset:9728
    s_add_u32 s57, s56, 1171456
    buffer_load_dwordx4 v[136:139], v2, s[28:31], s57 offen offset:2048 sc1
    s_waitcnt lgkmcnt(7)
    ds_read_b128 v[48:51], v12 offset:1536
    ds_read_b128 v[52:55], v12 offset:1568
    ds_read_b128 v[56:59], v12 offset:1600
    ds_read_b128 v[60:63], v12 offset:1632
    ds_read_b128 v[64:67], v12 offset:2048
    ds_read_b128 v[68:71], v12 offset:2080
    ds_read_b128 v[72:75], v12 offset:2112
    ds_read_b128 v[76:79], v12 offset:2144
    s_waitcnt vmcnt(12)
    v_mfma_f32_32x32x16_bf16 v[144:159], v[212:215], v[88:91], v[144:159]
    s_waitcnt lgkmcnt(14)
    ds_read_b64_tr_b16 v[200:201], v6 offset:11264
    s_waitcnt lgkmcnt(14)
    ds_read_b64_tr_b16 v[202:203], v6 offset:12800
    s_waitcnt vmcnt(11)
    v_mfma_f32_32x32x16_bf16 v[144:159], v[216:219], v[92:95], v[144:159]
    s_waitcnt lgkmcnt(14)
    ds_read_b64_tr_b16 v[204:205], v6 offset:14336
    s_waitcnt lgkmcnt(14)
    ds_read_b64_tr_b16 v[206:207], v6 offset:15872
    buffer_load_dwordx4 v[140:143], v2, s[28:31], s57 offen offset:3072 sc1
    s_mov_b64 exec, 1
    ds_add_u32 v246, v247 offset:2816
    s_mov_b64 exec, -1
    s_waitcnt vmcnt(11)
    v_mfma_f32_32x32x16_bf16 v[144:159], v[220:223], v[96:99], v[144:159]
    s_waitcnt lgkmcnt(14)
    ds_read_b64_tr_b16 v[208:209], v6 offset:17408
    s_waitcnt lgkmcnt(14)
    ds_read_b64_tr_b16 v[210:211], v6 offset:18944
    s_waitcnt vmcnt(10)
    v_mfma_f32_32x32x16_bf16 v[144:159], v[224:227], v[100:103], v[144:159]
    s_waitcnt lgkmcnt(14)
    ds_read_b64_tr_b16 v[212:213], v6 offset:20480
    s_waitcnt lgkmcnt(14)
    ds_read_b64_tr_b16 v[214:215], v6 offset:22016
    s_waitcnt lgkmcnt(9)
    v_fmac_f32 v64, v245, v48
    v_fmac_f32 v65, v245, v49
    v_fmac_f32 v66, v245, v50
    v_fmac_f32 v67, v245, v51
    s_waitcnt vmcnt(9)
    v_mfma_f32_32x32x16_bf16 v[144:159], v[192:195], v[104:107], v[144:159]
    ds_read_b64_tr_b16 v[216:217], v6 offset:23552
    ds_read_b64_tr_b16 v[218:219], v6 offset:25088
    v_fmac_f32 v68, v245, v52
    v_fmac_f32 v69, v245, v53
    v_fmac_f32 v70, v245, v54
    v_fmac_f32 v71, v245, v55
    s_waitcnt vmcnt(8)
    v_mfma_f32_32x32x16_bf16 v[144:159], v[196:199], v[108:111], v[144:159]
    ds_read_b64_tr_b16 v[220:221], v6 offset:26624
    ds_read_b64_tr_b16 v[222:223], v6 offset:28160
    v_fmac_f32 v72, v245, v56
    v_fmac_f32 v73, v245, v57
    v_fmac_f32 v74, v245, v58
    v_fmac_f32 v75, v245, v59
    s_waitcnt vmcnt(7)
    s_waitcnt lgkmcnt(11)
    v_mfma_f32_32x32x16_bf16 v[144:159], v[200:203], v[112:115], v[144:159]
    ds_read_b64_tr_b16 v[224:225], v6 offset:29696
    ds_read_b64_tr_b16 v[226:227], v6 offset:31232
    v_fmac_f32 v76, v245, v60
    v_fmac_f32 v77, v245, v61
    v_fmac_f32 v78, v245, v62
    v_fmac_f32 v79, v245, v63
    s_waitcnt vmcnt(6)
    s_waitcnt lgkmcnt(11)
    v_mfma_f32_32x32x16_bf16 v[144:159], v[204:207], v[116:119], v[144:159]
    ds_read_b64_tr_b16 v[192:193], v6 offset:32768
    ds_read_b64_tr_b16 v[194:195], v6 offset:34304
    s_waitcnt vmcnt(5)
    s_waitcnt lgkmcnt(10)
    v_mfma_f32_32x32x16_bf16 v[144:159], v[208:211], v[120:123], v[144:159]
    ds_read_b64_tr_b16 v[196:197], v3 offset:52288
    ds_read_b64_tr_b16 v[198:199], v3 offset:53824
    s_waitcnt vmcnt(4)
    s_waitcnt lgkmcnt(10)
    v_mfma_f32_32x32x16_bf16 v[144:159], v[212:215], v[124:127], v[144:159]
    ds_read_b64_tr_b16 v[200:201], v3 offset:55360
    ds_read_b64_tr_b16 v[202:203], v3 offset:56896
    s_waitcnt vmcnt(3)
    s_waitcnt lgkmcnt(10)
    v_mfma_f32_32x32x16_bf16 v[144:159], v[216:219], v[128:131], v[144:159]
    ds_read_b64_tr_b16 v[204:205], v3 offset:58432
    ds_read_b64_tr_b16 v[206:207], v3 offset:59968
    s_waitcnt vmcnt(2)
    s_waitcnt lgkmcnt(10)
    v_mfma_f32_32x32x16_bf16 v[144:159], v[220:223], v[132:135], v[144:159]
    ds_read_b64_tr_b16 v[208:209], v3 offset:61504
    ds_read_b64_tr_b16 v[210:211], v3 offset:63040
    s_waitcnt vmcnt(1)
    s_waitcnt lgkmcnt(10)
    v_mfma_f32_32x32x16_bf16 v[144:159], v[224:227], v[136:139], v[144:159]
    ds_read_b64_tr_b16 v[212:213], v3 offset:64576
    ds_read_b64_tr_b16 v[214:215], v6 offset:576
    s_waitcnt vmcnt(0)
    s_waitcnt lgkmcnt(10)
    v_mfma_f32_32x32x16_bf16 v[144:159], v[192:195], v[140:143], v[144:159]
    ds_read_b64_tr_b16 v[216:217], v6 offset:2112
    ds_read_b64_tr_b16 v[218:219], v6 offset:3648
    s_waitcnt lgkmcnt(10)
    v_mfma_f32_32x32x16_bf16 v[160:175], v[196:199], v[80:83], v[160:175]
    ds_read_b64_tr_b16 v[220:221], v6 offset:5184
    ds_read_b64_tr_b16 v[222:223], v6 offset:6720
    s_waitcnt lgkmcnt(10)
    v_mfma_f32_32x32x16_bf16 v[160:175], v[200:203], v[84:87], v[160:175]
    ds_read_b64_tr_b16 v[224:225], v6 offset:8256
    ds_read_b64_tr_b16 v[226:227], v6 offset:9792
    s_nop 1
    v_fmac_f32 v64, v144, v244
    v_fmac_f32 v65, v145, v244
    v_max_f32 v64, 0, v64
    v_fmac_f32 v66, v146, v244
    v_max_f32 v65, 0, v65
    v_mul_f32 v64, v64, v64
    s_waitcnt lgkmcnt(10)
    v_mfma_f32_32x32x16_bf16 v[160:175], v[204:207], v[88:91], v[160:175]
    ds_read_b64_tr_b16 v[192:193], v6 offset:11328
    ds_read_b64_tr_b16 v[194:195], v6 offset:12864
    v_fmac_f32 v67, v147, v244
    v_max_f32 v66, 0, v66
    v_mul_f32 v65, v65, v65
    v_fmac_f32 v68, v148, v244
    v_max_f32 v67, 0, v67
    v_mul_f32 v66, v66, v66
    s_waitcnt lgkmcnt(10)
    v_mfma_f32_32x32x16_bf16 v[160:175], v[208:211], v[92:95], v[160:175]
    ds_read_b64_tr_b16 v[196:197], v6 offset:14400
    ds_read_b64_tr_b16 v[198:199], v6 offset:15936
    v_cvt_pk_bf16_f32 v228, v64, v65
    v_fmac_f32 v69, v149, v244
    v_max_f32 v68, 0, v68
    v_mul_f32 v67, v67, v67
    v_fmac_f32 v70, v150, v244
    v_max_f32 v69, 0, v69
    s_waitcnt lgkmcnt(10)
    v_mfma_f32_32x32x16_bf16 v[160:175], v[212:215], v[96:99], v[160:175]
    ds_read_b64_tr_b16 v[200:201], v6 offset:17472
    ds_read_b64_tr_b16 v[202:203], v6 offset:19008
    v_mul_f32 v68, v68, v68
    v_cvt_pk_bf16_f32 v229, v66, v67
    v_fmac_f32 v71, v151, v244
    v_max_f32 v70, 0, v70
    v_mul_f32 v69, v69, v69
    v_fmac_f32 v72, v152, v244
    s_waitcnt lgkmcnt(10)
    v_mfma_f32_32x32x16_bf16 v[160:175], v[216:219], v[100:103], v[160:175]
    ds_read_b64_tr_b16 v[204:205], v6 offset:20544
    ds_read_b64_tr_b16 v[206:207], v6 offset:22080
    v_max_f32 v71, 0, v71
    v_mul_f32 v70, v70, v70
    v_cvt_pk_bf16_f32 v230, v68, v69
    v_fmac_f32 v73, v153, v244
    v_max_f32 v72, 0, v72
    v_mul_f32 v71, v71, v71
    s_waitcnt lgkmcnt(10)
    v_mfma_f32_32x32x16_bf16 v[160:175], v[220:223], v[104:107], v[160:175]
    ds_read_b64_tr_b16 v[208:209], v6 offset:23616
    ds_read_b64_tr_b16 v[210:211], v6 offset:25152
    v_fmac_f32 v74, v154, v244
    v_max_f32 v73, 0, v73
    v_mul_f32 v72, v72, v72
    v_cvt_pk_bf16_f32 v231, v70, v71
    v_fmac_f32 v75, v155, v244
    v_max_f32 v74, 0, v74
    s_waitcnt lgkmcnt(10)
    v_mfma_f32_32x32x16_bf16 v[160:175], v[224:227], v[108:111], v[160:175]
    ds_read_b64_tr_b16 v[212:213], v6 offset:26688
    ds_read_b64_tr_b16 v[214:215], v6 offset:28224
    v_mul_f32 v73, v73, v73
    v_fmac_f32 v76, v156, v244
    v_max_f32 v75, 0, v75
    v_mul_f32 v74, v74, v74
    v_cvt_pk_bf16_f32 v232, v72, v73
    v_fmac_f32 v77, v157, v244
    s_waitcnt lgkmcnt(10)
    v_mfma_f32_32x32x16_bf16 v[160:175], v[192:195], v[112:115], v[160:175]
    ds_read_b64_tr_b16 v[216:217], v6 offset:29760
    ds_read_b64_tr_b16 v[218:219], v6 offset:31296
    v_max_f32 v76, 0, v76
    v_mul_f32 v75, v75, v75
    v_fmac_f32 v78, v158, v244
    v_max_f32 v77, 0, v77
    v_mul_f32 v76, v76, v76
    v_cvt_pk_bf16_f32 v233, v74, v75
    s_waitcnt lgkmcnt(10)
    v_mfma_f32_32x32x16_bf16 v[160:175], v[196:199], v[116:119], v[160:175]
    ds_read_b64_tr_b16 v[220:221], v6 offset:32832
    ds_read_b64_tr_b16 v[222:223], v6 offset:34368
    v_fmac_f32 v79, v159, v244
    v_max_f32 v78, 0, v78
    v_mul_f32 v77, v77, v77
    v_max_f32 v79, 0, v79
    v_mul_f32 v78, v78, v78
    v_mul_f32 v79, v79, v79
    s_waitcnt lgkmcnt(10)
    v_mfma_f32_32x32x16_bf16 v[160:175], v[200:203], v[120:123], v[160:175]
    ds_read_b64_tr_b16 v[224:225], v3 offset:52352
    ds_read_b64_tr_b16 v[226:227], v3 offset:53888
    v_cvt_pk_bf16_f32 v234, v76, v77
    v_cvt_pk_bf16_f32 v235, v78, v79
    buffer_store_dwordx4 v[228:231], v2, s[28:31], s59 offen offset:0 sc1
    buffer_store_dwordx4 v[232:235], v2, s[28:31], s59 offen offset:1024 sc1
    s_waitcnt lgkmcnt(10)
    v_mfma_f32_32x32x16_bf16 v[160:175], v[204:207], v[124:127], v[160:175]
    ds_read_b64_tr_b16 v[192:193], v3 offset:55424
    ds_read_b64_tr_b16 v[194:195], v3 offset:56960
    s_waitcnt lgkmcnt(7)
    ds_read_b128 v[16:19], v12 offset:1664
    ds_read_b128 v[20:23], v12 offset:1696
    ds_read_b128 v[24:27], v12 offset:1728
    ds_read_b128 v[28:31], v12 offset:1760
    ds_read_b128 v[32:35], v12 offset:2176
    ds_read_b128 v[36:39], v12 offset:2208
    ds_read_b128 v[40:43], v12 offset:2240
    ds_read_b128 v[44:47], v12 offset:2272
    v_mfma_f32_32x32x16_bf16 v[160:175], v[208:211], v[128:131], v[160:175]
    s_waitcnt lgkmcnt(14)
    ds_read_b64_tr_b16 v[196:197], v3 offset:58496
    s_waitcnt lgkmcnt(14)
    ds_read_b64_tr_b16 v[198:199], v3 offset:60032
    v_mfma_f32_32x32x16_bf16 v[160:175], v[212:215], v[132:135], v[160:175]
    s_waitcnt lgkmcnt(14)
    ds_read_b64_tr_b16 v[200:201], v3 offset:61568
    s_waitcnt lgkmcnt(14)
    ds_read_b64_tr_b16 v[202:203], v3 offset:63104
    s_waitcnt lgkmcnt(4)
    v_fmac_f32 v32, v245, v16
    v_fmac_f32 v33, v245, v17
    v_fmac_f32 v34, v245, v18
    v_fmac_f32 v35, v245, v19
    v_fmac_f32 v36, v245, v20
    v_fmac_f32 v37, v245, v21
    v_mfma_f32_32x32x16_bf16 v[160:175], v[216:219], v[136:139], v[160:175]
    ds_read_b64_tr_b16 v[204:205], v3 offset:64640
    ds_read_b64_tr_b16 v[206:207], v6 offset:640
    v_fmac_f32 v38, v245, v22
    v_fmac_f32 v39, v245, v23
    v_fmac_f32 v40, v245, v24
    v_fmac_f32 v41, v245, v25
    v_fmac_f32 v42, v245, v26
    v_fmac_f32 v43, v245, v27
    v_mfma_f32_32x32x16_bf16 v[160:175], v[220:223], v[140:143], v[160:175]
    ds_read_b64_tr_b16 v[208:209], v6 offset:2176
    ds_read_b64_tr_b16 v[210:211], v6 offset:3712
    v_fmac_f32 v44, v245, v28
    v_fmac_f32 v45, v245, v29
    v_fmac_f32 v46, v245, v30
    v_fmac_f32 v47, v245, v31
    v_mfma_f32_32x32x16_bf16 v[176:191], v[224:227], v[80:83], v[176:191]
    ds_read_b64_tr_b16 v[212:213], v6 offset:5248
    ds_read_b64_tr_b16 v[214:215], v6 offset:6784
    v_mfma_f32_32x32x16_bf16 v[176:191], v[192:195], v[84:87], v[176:191]
    ds_read_b64_tr_b16 v[216:217], v6 offset:8320
    ds_read_b64_tr_b16 v[218:219], v6 offset:9856
    v_fmac_f32 v32, v160, v244
    v_fmac_f32 v33, v161, v244
    v_max_f32 v32, 0, v32
    v_fmac_f32 v34, v162, v244
    v_max_f32 v33, 0, v33
    v_mul_f32 v32, v32, v32
    s_waitcnt lgkmcnt(10)
    v_mfma_f32_32x32x16_bf16 v[176:191], v[196:199], v[88:91], v[176:191]
    ds_read_b64_tr_b16 v[220:221], v6 offset:11392
    ds_read_b64_tr_b16 v[222:223], v6 offset:12928
    v_fmac_f32 v35, v163, v244
    v_max_f32 v34, 0, v34
    v_mul_f32 v33, v33, v33
    v_fmac_f32 v36, v164, v244
    v_max_f32 v35, 0, v35
    v_mul_f32 v34, v34, v34
    s_waitcnt lgkmcnt(10)
    v_mfma_f32_32x32x16_bf16 v[176:191], v[200:203], v[92:95], v[176:191]
    ds_read_b64_tr_b16 v[224:225], v6 offset:14464
    ds_read_b64_tr_b16 v[226:227], v6 offset:16000
    v_cvt_pk_bf16_f32 v236, v32, v33
    v_fmac_f32 v37, v165, v244
    v_max_f32 v36, 0, v36
    v_mul_f32 v35, v35, v35
    v_fmac_f32 v38, v166, v244
    v_max_f32 v37, 0, v37
    s_waitcnt lgkmcnt(10)
    v_mfma_f32_32x32x16_bf16 v[176:191], v[204:207], v[96:99], v[176:191]
    ds_read_b64_tr_b16 v[192:193], v6 offset:17536
    ds_read_b64_tr_b16 v[194:195], v6 offset:19072
    v_mul_f32 v36, v36, v36
    v_cvt_pk_bf16_f32 v237, v34, v35
    v_fmac_f32 v39, v167, v244
    v_max_f32 v38, 0, v38
    v_mul_f32 v37, v37, v37
    v_fmac_f32 v40, v168, v244
    s_waitcnt lgkmcnt(10)
    v_mfma_f32_32x32x16_bf16 v[176:191], v[208:211], v[100:103], v[176:191]
    ds_read_b64_tr_b16 v[196:197], v6 offset:20608
    ds_read_b64_tr_b16 v[198:199], v6 offset:22144
    v_max_f32 v39, 0, v39
    v_mul_f32 v38, v38, v38
    v_cvt_pk_bf16_f32 v238, v36, v37
    v_fmac_f32 v41, v169, v244
    v_max_f32 v40, 0, v40
    v_mul_f32 v39, v39, v39
    s_waitcnt lgkmcnt(10)
    v_mfma_f32_32x32x16_bf16 v[176:191], v[212:215], v[104:107], v[176:191]
    ds_read_b64_tr_b16 v[200:201], v6 offset:23680
    ds_read_b64_tr_b16 v[202:203], v6 offset:25216
    v_fmac_f32 v42, v170, v244
    v_max_f32 v41, 0, v41
    v_mul_f32 v40, v40, v40
    v_cvt_pk_bf16_f32 v239, v38, v39
    v_fmac_f32 v43, v171, v244
    v_max_f32 v42, 0, v42
    s_waitcnt lgkmcnt(10)
    v_mfma_f32_32x32x16_bf16 v[176:191], v[216:219], v[108:111], v[176:191]
    ds_read_b64_tr_b16 v[204:205], v6 offset:26752
    ds_read_b64_tr_b16 v[206:207], v6 offset:28288
    v_mul_f32 v41, v41, v41
    v_fmac_f32 v44, v172, v244
    v_max_f32 v43, 0, v43
    v_mul_f32 v42, v42, v42
    v_cvt_pk_bf16_f32 v240, v40, v41
    v_fmac_f32 v45, v173, v244
    s_waitcnt lgkmcnt(10)
    v_mfma_f32_32x32x16_bf16 v[176:191], v[220:223], v[112:115], v[176:191]
    ds_read_b64_tr_b16 v[208:209], v6 offset:29824
    ds_read_b64_tr_b16 v[210:211], v6 offset:31360
    v_max_f32 v44, 0, v44
    v_mul_f32 v43, v43, v43
    v_fmac_f32 v46, v174, v244
    v_max_f32 v45, 0, v45
    v_mul_f32 v44, v44, v44
    v_cvt_pk_bf16_f32 v241, v42, v43
    s_waitcnt lgkmcnt(10)
    v_mfma_f32_32x32x16_bf16 v[176:191], v[224:227], v[116:119], v[176:191]
    ds_read_b64_tr_b16 v[212:213], v6 offset:32896
    ds_read_b64_tr_b16 v[214:215], v6 offset:34432
    v_fmac_f32 v47, v175, v244
    v_max_f32 v46, 0, v46
    v_mul_f32 v45, v45, v45
    v_max_f32 v47, 0, v47
    v_mul_f32 v46, v46, v46
    v_mul_f32 v47, v47, v47
    s_waitcnt lgkmcnt(10)
    v_mfma_f32_32x32x16_bf16 v[176:191], v[192:195], v[120:123], v[176:191]
    v_cvt_pk_bf16_f32 v242, v44, v45
    v_cvt_pk_bf16_f32 v243, v46, v47
    buffer_store_dwordx4 v[236:239], v2, s[28:31], s59 offen offset:2048 sc1
    buffer_store_dwordx4 v[240:243], v2, s[28:31], s59 offen offset:3072 sc1
    s_waitcnt lgkmcnt(8)
    v_mfma_f32_32x32x16_bf16 v[176:191], v[196:199], v[124:127], v[176:191]
    s_waitcnt lgkmcnt(7)
    ds_read_b128 v[48:51], v12 offset:1792
    ds_read_b128 v[52:55], v12 offset:1824
    ds_read_b128 v[56:59], v12 offset:1856
    ds_read_b128 v[60:63], v12 offset:1888
    ds_read_b128 v[64:67], v12 offset:2304
    ds_read_b128 v[68:71], v12 offset:2336
    ds_read_b128 v[72:75], v12 offset:2368
    ds_read_b128 v[76:79], v12 offset:2400
    s_waitcnt lgkmcnt(14)
    v_mfma_f32_32x32x16_bf16 v[176:191], v[200:203], v[128:131], v[176:191]
    s_waitcnt lgkmcnt(12)
    v_mfma_f32_32x32x16_bf16 v[176:191], v[204:207], v[132:135], v[176:191]
    s_waitcnt lgkmcnt(0)
    v_fmac_f32 v64, v245, v48
    v_fmac_f32 v65, v245, v49
    v_fmac_f32 v66, v245, v50
    v_fmac_f32 v67, v245, v51
    v_fmac_f32 v68, v245, v52
    v_fmac_f32 v69, v245, v53
    v_mfma_f32_32x32x16_bf16 v[176:191], v[208:211], v[136:139], v[176:191]
    v_fmac_f32 v70, v245, v54
    v_fmac_f32 v71, v245, v55
    v_fmac_f32 v72, v245, v56
    v_fmac_f32 v73, v245, v57
    v_fmac_f32 v74, v245, v58
    v_fmac_f32 v75, v245, v59
    v_mfma_f32_32x32x16_bf16 v[176:191], v[212:215], v[140:143], v[176:191]
    v_fmac_f32 v76, v245, v60
    v_fmac_f32 v77, v245, v61
    v_fmac_f32 v78, v245, v62
    v_fmac_f32 v79, v245, v63
    v_lshrrev_b32 v10, 5, v1
    v_lshlrev_b32 v10, 3, v10
    s_lshl_b32 s55, s49, 7
    s_lshl_b32 s56, s95, 6
    s_add_u32 s55, s55, s56
    buffer_load_dwordx2 v[200:201], v10, s[36:39], s55 offen offset:0
    buffer_load_dwordx2 v[202:203], v10, s[36:39], s55 offen offset:16
    buffer_load_dwordx2 v[204:205], v10, s[36:39], s55 offen offset:32
    buffer_load_dwordx2 v[206:207], v10, s[36:39], s55 offen offset:48
    v_fmac_f32 v64, v176, v244
    v_fmac_f32 v65, v177, v244
    v_max_f32 v64, 0, v64
    v_fmac_f32 v66, v178, v244
    v_max_f32 v65, 0, v65
    v_mul_f32 v64, v64, v64
    v_fmac_f32 v67, v179, v244
    v_max_f32 v66, 0, v66
    v_mul_f32 v65, v65, v65
    v_fmac_f32 v68, v180, v244
    v_max_f32 v67, 0, v67
    v_mul_f32 v66, v66, v66
    v_cvt_pk_bf16_f32 v228, v64, v65
    v_fmac_f32 v69, v181, v244
    v_max_f32 v68, 0, v68
    v_mul_f32 v67, v67, v67
    v_fmac_f32 v70, v182, v244
    v_max_f32 v69, 0, v69
    v_mul_f32 v68, v68, v68
    v_cvt_pk_bf16_f32 v229, v66, v67
    v_fmac_f32 v71, v183, v244
    v_max_f32 v70, 0, v70
    v_mul_f32 v69, v69, v69
    v_fmac_f32 v72, v184, v244
    v_max_f32 v71, 0, v71
    v_mul_f32 v70, v70, v70
    v_cvt_pk_bf16_f32 v230, v68, v69
    v_fmac_f32 v73, v185, v244
    v_max_f32 v72, 0, v72
    v_mul_f32 v71, v71, v71
    v_fmac_f32 v74, v186, v244
    v_max_f32 v73, 0, v73
    v_mul_f32 v72, v72, v72
    v_cvt_pk_bf16_f32 v231, v70, v71
    v_fmac_f32 v75, v187, v244
    v_max_f32 v74, 0, v74
    v_mul_f32 v73, v73, v73
    v_fmac_f32 v76, v188, v244
    v_max_f32 v75, 0, v75
    v_mul_f32 v74, v74, v74
    v_cvt_pk_bf16_f32 v232, v72, v73
    v_fmac_f32 v77, v189, v244
    v_max_f32 v76, 0, v76
    v_mul_f32 v75, v75, v75
    v_fmac_f32 v78, v190, v244
    v_max_f32 v77, 0, v77
    v_mul_f32 v76, v76, v76
    v_cvt_pk_bf16_f32 v233, v74, v75
    v_fmac_f32 v79, v191, v244
    v_max_f32 v78, 0, v78
    v_mul_f32 v77, v77, v77
    v_max_f32 v79, 0, v79
    v_mul_f32 v78, v78, v78
    v_mul_f32 v79, v79, v79
    v_cvt_pk_bf16_f32 v234, v76, v77
    v_cvt_pk_bf16_f32 v235, v78, v79
    s_cmp_eq_u32 s53, 1
    s_cbranch_scc0 L_safe_92
    buffer_store_dwordx4 v[228:231], v2, s[28:31], s60 offen offset:0
    buffer_store_dwordx4 v[232:235], v2, s[28:31], s60 offen offset:1024
L_back_93:
    s_lshl_b32 s55, s95, 13
    s_add_u32 s55, s55, 101376
    v_add_u32 v6, s55, v4
    v_add_u32 v7, s55, v5
    ds_read_b64_tr_b16 v[16:17], v6 offset:0
    ds_read_b64_tr_b16 v[18:19], v6 offset:1024
    ds_read_b64_tr_b16 v[20:21], v7 offset:0
    ds_read_b64_tr_b16 v[22:23], v7 offset:1024
    ds_read_b64_tr_b16 v[24:25], v6 offset:2048
    ds_read_b64_tr_b16 v[26:27], v6 offset:3072
    ds_read_b64_tr_b16 v[28:29], v7 offset:2048
    ds_read_b64_tr_b16 v[30:31], v7 offset:3072
    s_waitcnt lgkmcnt(4)
    ds_read_b64_tr_b16 v[32:33], v6 offset:4096
    ds_read_b64_tr_b16 v[34:35], v6 offset:5120
    ds_read_b64_tr_b16 v[36:37], v7 offset:4096
    ds_read_b64_tr_b16 v[38:39], v7 offset:5120
    ds_read_b64_tr_b16 v[40:41], v6 offset:6144
    ds_read_b64_tr_b16 v[42:43], v6 offset:7168
    ds_read_b64_tr_b16 v[44:45], v7 offset:6144
    ds_read_b64_tr_b16 v[46:47], v7 offset:7168
    s_mov_b64 exec, 1
    ds_add_u32 v246, v247 offset:2820
    s_mov_b64 exec, -1
    s_mul_i32 s55, s95, 22528
    v_add_u32 v6, s55, v4
    v_add_u32 v7, s55, v5
    v_add_u32 v6, 0x10000, v6
    v_add_u32 v7, 0x10000, v7
    v_add_u32 v12, 0x10000, v6
    v_add_u32 v13, 0x10000, v7
    s_lshl_b32 s55, s95, 11
    v_add_u32 v4, s55, v4
    v_add_u32 v5, s55, v5
    v_add_u32 v14, 0x10000, v4
    v_add_u32 v15, 0x10000, v5
    s_waitcnt lgkmcnt(0)
    v_mov_b32 v10, s58
    v_mov_b32 v11, s52
    s_waitcnt vmcnt(0)
    s_mov_b64 exec, 1
    s_cmp_eq_u32 s53, 1
    s_cbranch_scc0 L_safe_94
    buffer_store_dword v11, v10, s[28:31], 0 offen
L_back_95:
    s_mov_b64 exec, -1
    v_and_b32 v10, 7, v1
    s_add_u32 s55, s95, 6
    v_min_u32 v10, s55, v10
    v_lshlrev_b32 v10, 2, v10
    s_lshl_b32 s56, s64, 7
    s_mul_i32 s55, s95, 28
    s_add_u32 s56, s56, s55
    s_add_u32 s56, s56, 57344
    v_add_u32 v10, s56, v10
    s_lshl_b32 s56, s46, 18
    s_mul_i32 s57, s95, 114688
    s_add_u32 s56, s56, s57
    s_and_b32 s57, s64, 3
    s_lshl_b32 s57, s57, 12
    s_add_u32 s56, s56, s57
    s_lshl_b32 s58, s64, 16
    s_mul_i32 s57, s95, 28672
    s_add_u32 s58, s58, s57
    v_lshlrev_b32 v48, 16, v248
    v_and_b32 v49, 0xffff0000, v248
    v_lshlrev_b32 v64, 16, v200
    v_and_b32 v65, 0xffff0000, v200
    v_add_f32 v48, v48, v64
    v_add_f32 v49, v49, v65
    v_lshlrev_b32 v50, 16, v249
    v_and_b32 v51, 0xffff0000, v249
    v_lshlrev_b32 v64, 16, v201
    v_and_b32 v65, 0xffff0000, v201
    v_add_f32 v50, v50, v64
    v_add_f32 v51, v51, v65
    v_lshlrev_b32 v52, 16, v250
    v_and_b32 v53, 0xffff0000, v250
    v_lshlrev_b32 v64, 16, v202
    v_and_b32 v65, 0xffff0000, v202
    v_add_f32 v52, v52, v64
    v_add_f32 v53, v53, v65
    v_lshlrev_b32 v54, 16, v251
    v_and_b32 v55, 0xffff0000, v251
    v_lshlrev_b32 v64, 16, v203
    v_and_b32 v65, 0xffff0000, v203
    v_add_f32 v54, v54, v64
    v_add_f32 v55, v55, v65
    v_lshlrev_b32 v56, 16, v252
    v_and_b32 v57, 0xffff0000, v252
    v_lshlrev_b32 v64, 16, v204
    v_and_b32 v65, 0xffff0000, v204
    v_add_f32 v56, v56, v64
    v_add_f32 v57, v57, v65
    v_lshlrev_b32 v58, 16, v253
    v_and_b32 v59, 0xffff0000, v253
    v_lshlrev_b32 v64, 16, v205
    v_and_b32 v65, 0xffff0000, v205
    v_add_f32 v58, v58, v64
    v_add_f32 v59, v59, v65
    v_lshlrev_b32 v60, 16, v254
    v_and_b32 v61, 0xffff0000, v254
    v_lshlrev_b32 v64, 16, v206
    v_and_b32 v65, 0xffff0000, v206
    v_add_f32 v60, v60, v64
    v_add_f32 v61, v61, v65
    v_lshlrev_b32 v62, 16, v255
    v_and_b32 v63, 0xffff0000, v255
    v_lshlrev_b32 v64, 16, v207
    v_and_b32 v65, 0xffff0000, v207
    v_add_f32 v62, v62, v64
    v_add_f32 v63, v63, v65
    s_mov_b32 s55, 0
L_poll_96:
    buffer_load_dword v11, v10, s[28:31], 0 offen sc1
    s_waitcnt vmcnt(0)
    v_cmp_ne_u32 vcc, s52, v11
    s_cbranch_vccnz L_pollx_98
L_polld_97:
    s_add_u32 s57, s56, 1048576
    buffer_load_dwordx4 v[136:139], v2, s[28:31], s57 offen offset:0 sc1
    buffer_load_dwordx4 v[140:143], v2, s[28:31], s57 offen offset:1024 sc1
    s_add_u32 s57, s56, 1064960
    buffer_load_dwordx4 v[144:147], v2, s[28:31], s57 offen offset:0 sc1
    buffer_load_dwordx4 v[148:151], v2, s[28:31], s57 offen offset:1024 sc1
    s_add_u32 s57, s56, 1081344
    buffer_load_dwordx4 v[152:155], v2, s[28:31], s57 offen offset:0 sc1
    buffer_load_dwordx4 v[156:159], v2, s[28:31], s57 offen offset:1024 sc1
    s_add_u32 s57, s56, 1097728
    buffer_load_dwordx4 v[160:163], v2, s[28:31], s57 offen offset:0 sc1
    buffer_load_dwordx4 v[164:167], v2, s[28:31], s57 offen offset:1024 sc1
    s_add_u32 s57, s56, 1114112
    buffer_load_dwordx4 v[168:171], v2, s[28:31], s57 offen offset:0 sc1
    buffer_load_dwordx4 v[172:175], v2, s[28:31], s57 offen offset:1024 sc1
    ds_read_b32 v10, v246 offset:2828
    s_waitcnt lgkmcnt(0)
    v_cmp_gt_u32 vcc, 4, v10
    s_cbranch_vccnz L_lwx_100
L_lw_99:
    ds_read_b64_tr_b16 v[116:117], v7 offset:53248
    ds_read_b64_tr_b16 v[118:119], v7 offset:54272
    ds_read_b64_tr_b16 v[112:113], v6 offset:53248
    ds_read_b64_tr_b16 v[114:115], v6 offset:54272
    ds_read_b64_tr_b16 v[124:125], v7 offset:55296
    ds_read_b64_tr_b16 v[126:127], v7 offset:56320
    ds_read_b64_tr_b16 v[120:121], v6 offset:55296
    ds_read_b64_tr_b16 v[122:123], v6 offset:56320
    s_waitcnt vmcnt(9)
    v_mfma_f32_32x32x16_bf16 v[64:79], v[20:23], v[136:139], 0
    v_mfma_f32_32x32x16_bf16 v[48:63], v[16:19], v[136:139], v[48:63]
    s_add_u32 s57, s56, 1130496
    buffer_load_dwordx4 v[176:179], v2, s[28:31], s57 offen offset:0 sc1
    s_waitcnt vmcnt(9)
    v_mfma_f32_32x32x16_bf16 v[64:79], v[28:31], v[140:143], v[64:79]
    v_mfma_f32_32x32x16_bf16 v[48:63], v[24:27], v[140:143], v[48:63]
    buffer_load_dwordx4 v[180:183], v2, s[28:31], s57 offen offset:1024 sc1
    s_waitcnt vmcnt(9)
    v_mfma_f32_32x32x16_bf16 v[64:79], v[36:39], v[144:147], v[64:79]
    v_mfma_f32_32x32x16_bf16 v[48:63], v[32:35], v[144:147], v[48:63]
    s_add_u32 s57, s56, 1146880
    buffer_load_dwordx4 v[184:187], v2, s[28:31], s57 offen offset:0 sc1
    s_waitcnt vmcnt(9)
    v_mfma_f32_32x32x16_bf16 v[64:79], v[44:47], v[148:151], v[64:79]
    v_mfma_f32_32x32x16_bf16 v[48:63], v[40:43], v[148:151], v[48:63]
    buffer_load_dwordx4 v[188:191], v2, s[28:31], s57 offen offset:1024 sc1
    s_waitcnt vmcnt(9)
    s_waitcnt lgkmcnt(4)
    v_mfma_f32_32x32x16_bf16 v[64:79], v[116:119], v[152:155], v[64:79]
    ds_read_b64_tr_b16 v[132:133], v7 offset:57344
    ds_read_b64_tr_b16 v[134:135], v7 offset:58368
    ds_read_b64_tr_b16 v[128:129], v6 offset:57344
    ds_read_b64_tr_b16 v[130:131], v6 offset:58368
    v_mfma_f32_32x32x16_bf16 v[48:63], v[112:115], v[152:155], v[48:63]
    s_add_u32 s57, s58, 6291456
    buffer_load_dwordx4 v[192:195], v2, s[28:31], s57 offen offset:0 sc1
    s_waitcnt vmcnt(9)
    s_waitcnt lgkmcnt(4)
    v_mfma_f32_32x32x16_bf16 v[64:79], v[124:127], v[156:159], v[64:79]
    ds_read_b64_tr_b16 v[84:85], v7 offset:59392
    ds_read_b64_tr_b16 v[86:87], v7 offset:60416
    ds_read_b64_tr_b16 v[80:81], v6 offset:59392
    ds_read_b64_tr_b16 v[82:83], v6 offset:60416
    v_mfma_f32_32x32x16_bf16 v[48:63], v[120:123], v[156:159], v[48:63]
    buffer_load_dwordx4 v[196:199], v2, s[28:31], s57 offen offset:1024 sc1
    s_waitcnt vmcnt(9)
    s_waitcnt lgkmcnt(4)
    v_mfma_f32_32x32x16_bf16 v[64:79], v[132:135], v[160:163], v[64:79]
    ds_read_b64_tr_b16 v[92:93], v7 offset:61440
    ds_read_b64_tr_b16 v[94:95], v7 offset:62464
    ds_read_b64_tr_b16 v[88:89], v6 offset:61440
    ds_read_b64_tr_b16 v[90:91], v6 offset:62464
    v_mfma_f32_32x32x16_bf16 v[48:63], v[128:131], v[160:163], v[48:63]
    buffer_load_dwordx4 v[136:139], v2, s[28:31], s57 offen offset:2048 sc1
    s_waitcnt vmcnt(9)
    s_waitcnt lgkmcnt(4)
    v_mfma_f32_32x32x16_bf16 v[64:79], v[84:87], v[164:167], v[64:79]
    ds_read_b64_tr_b16 v[100:101], v7 offset:63488
    ds_read_b64_tr_b16 v[102:103], v7 offset:64512
    ds_read_b64_tr_b16 v[96:97], v6 offset:63488
    ds_read_b64_tr_b16 v[98:99], v6 offset:64512
    v_mfma_f32_32x32x16_bf16 v[48:63], v[80:83], v[164:167], v[48:63]
    buffer_load_dwordx4 v[140:143], v2, s[28:31], s57 offen offset:3072 sc1
    s_waitcnt vmcnt(9)
    s_waitcnt lgkmcnt(4)
    v_mfma_f32_32x32x16_bf16 v[64:79], v[92:95], v[168:171], v[64:79]
    ds_read_b64_tr_b16 v[108:109], v13 offset:0
    ds_read_b64_tr_b16 v[110:111], v13 offset:1024
    ds_read_b64_tr_b16 v[104:105], v12 offset:0
    ds_read_b64_tr_b16 v[106:107], v12 offset:1024
    v_mfma_f32_32x32x16_bf16 v[48:63], v[88:91], v[168:171], v[48:63]
    s_add_u32 s57, s58, 6295552
    buffer_load_dwordx4 v[144:147], v2, s[28:31], s57 offen offset:0 sc1
    s_waitcnt vmcnt(9)
    s_waitcnt lgkmcnt(4)
    v_mfma_f32_32x32x16_bf16 v[64:79], v[100:103], v[172:175], v[64:79]
    ds_read_b64_tr_b16 v[116:117], v13 offset:2048
    ds_read_b64_tr_b16 v[118:119], v13 offset:3072
    ds_read_b64_tr_b16 v[112:113], v12 offset:2048
    ds_read_b64_tr_b16 v[114:115], v12 offset:3072
    v_mfma_f32_32x32x16_bf16 v[48:63], v[96:99], v[172:175], v[48:63]
    buffer_load_dwordx4 v[148:151], v2, s[28:31], s57 offen offset:1024 sc1
    ds_read_b32 v10, v246 offset:2832
    s_waitcnt vmcnt(9)
    s_waitcnt lgkmcnt(5)
    v_mfma_f32_32x32x16_bf16 v[64:79], v[108:111], v[176:179], v[64:79]
    ds_read_b64_tr_b16 v[124:125], v13 offset:4096
    ds_read_b64_tr_b16 v[126:127], v13 offset:5120
    ds_read_b64_tr_b16 v[120:121], v12 offset:4096
    ds_read_b64_tr_b16 v[122:123], v12 offset:5120
    v_mfma_f32_32x32x16_bf16 v[48:63], v[104:107], v[176:179], v[48:63]
    buffer_load_dwordx4 v[152:155], v2, s[28:31], s57 offen offset:2048 sc1
    s_waitcnt vmcnt(9)
    s_waitcnt lgkmcnt(5)
    v_mfma_f32_32x32x16_bf16 v[64:79], v[116:119], v[180:183], v[64:79]
    ds_read_b64_tr_b16 v[132:133], v13 offset:6144
    ds_read_b64_tr_b16 v[134:135], v13 offset:7168
    ds_read_b64_tr_b16 v[128:129], v12 offset:6144
    ds_read_b64_tr_b16 v[130:131], v12 offset:7168
    v_mfma_f32_32x32x16_bf16 v[48:63], v[112:115], v[180:183], v[48:63]
    buffer_load_dwordx4 v[156:159], v2, s[28:31], s57 offen offset:3072 sc1
    s_waitcnt vmcnt(9)
    s_waitcnt lgkmcnt(4)
    v_mfma_f32_32x32x16_bf16 v[64:79], v[124:127], v[184:187], v[64:79]
    ds_read_b64_tr_b16 v[84:85], v13 offset:8192
    ds_read_b64_tr_b16 v[86:87], v13 offset:9216
    ds_read_b64_tr_b16 v[80:81], v12 offset:8192
    ds_read_b64_tr_b16 v[82:83], v12 offset:9216
    v_cmp_gt_u32 vcc, 4, v10
    s_cbranch_vccnz L_lwx_102
L_lw_101:
    v_mfma_f32_32x32x16_bf16 v[48:63], v[120:123], v[184:187], v[48:63]
    s_add_u32 s57, s58, 6299648
    buffer_load_dwordx4 v[160:163], v2, s[28:31], s57 offen offset:0 sc1
    s_waitcnt vmcnt(9)
    s_waitcnt lgkmcnt(4)
    v_mfma_f32_32x32x16_bf16 v[64:79], v[132:135], v[188:191], v[64:79]
    ds_read_b64_tr_b16 v[92:93], v5 offset:3072
    ds_read_b64_tr_b16 v[94:95], v5 offset:4096
    ds_read_b64_tr_b16 v[88:89], v4 offset:3072
    ds_read_b64_tr_b16 v[90:91], v4 offset:4096
    v_mfma_f32_32x32x16_bf16 v[48:63], v[128:131], v[188:191], v[48:63]
    buffer_load_dwordx4 v[164:167], v2, s[28:31], s57 offen offset:1024 sc1
    s_waitcnt vmcnt(9)
    s_waitcnt lgkmcnt(4)
    v_mfma_f32_32x32x16_bf16 v[64:79], v[84:87], v[192:195], v[64:79]
    ds_read_b64_tr_b16 v[100:101], v5 offset:7168
    ds_read_b64_tr_b16 v[102:103], v5 offset:8192
    ds_read_b64_tr_b16 v[96:97], v4 offset:7168
    ds_read_b64_tr_b16 v[98:99], v4 offset:8192
    v_mfma_f32_32x32x16_bf16 v[48:63], v[80:83], v[192:195], v[48:63]
    buffer_load_dwordx4 v[168:171], v2, s[28:31], s57 offen offset:2048 sc1
    s_waitcnt vmcnt(9)
    s_waitcnt lgkmcnt(4)
    v_mfma_f32_32x32x16_bf16 v[64:79], v[92:95], v[196:199], v[64:79]
    ds_read_b64_tr_b16 v[108:109], v5 offset:11264
    ds_read_b64_tr_b16 v[110:111], v5 offset:12288
    ds_read_b64_tr_b16 v[104:105], v4 offset:11264
    ds_read_b64_tr_b16 v[106:107], v4 offset:12288
    v_mfma_f32_32x32x16_bf16 v[48:63], v[88:91], v[196:199], v[48:63]
    buffer_load_dwordx4 v[172:175], v2, s[28:31], s57 offen offset:3072 sc1
    s_waitcnt vmcnt(9)
    s_waitcnt lgkmcnt(4)
    v_mfma_f32_32x32x16_bf16 v[64:79], v[100:103], v[136:139], v[64:79]
    ds_read_b64_tr_b16 v[116:117], v5 offset:15360
    ds_read_b64_tr_b16 v[118:119], v5 offset:16384
    ds_read_b64_tr_b16 v[112:113], v4 offset:15360
    ds_read_b64_tr_b16 v[114:115], v4 offset:16384
    v_mfma_f32_32x32x16_bf16 v[48:63], v[96:99], v[136:139], v[48:63]
    s_add_u32 s57, s58, 6303744
    buffer_load_dwordx4 v[176:179], v2, s[28:31], s57 offen offset:0 sc1
    s_waitcnt vmcnt(9)
    s_waitcnt lgkmcnt(4)
    v_mfma_f32_32x32x16_bf16 v[64:79], v[108:111], v[140:143], v[64:79]
    ds_read_b64_tr_b16 v[124:125], v5 offset:19456
    ds_read_b64_tr_b16 v[126:127], v5 offset:20480
    ds_read_b64_tr_b16 v[120:121], v4 offset:19456
    ds_read_b64_tr_b16 v[122:123], v4 offset:20480
    v_mfma_f32_32x32x16_bf16 v[48:63], v[104:107], v[140:143], v[48:63]
    buffer_load_dwordx4 v[180:183], v2, s[28:31], s57 offen offset:1024 sc1
    s_waitcnt vmcnt(9)
    s_waitcnt lgkmcnt(4)
    v_mfma_f32_32x32x16_bf16 v[64:79], v[116:119], v[144:147], v[64:79]
    ds_read_b64_tr_b16 v[132:133], v5 offset:23552
    ds_read_b64_tr_b16 v[134:135], v5 offset:24576
    ds_read_b64_tr_b16 v[128:129], v4 offset:23552
    ds_read_b64_tr_b16 v[130:131], v4 offset:24576
    v_mfma_f32_32x32x16_bf16 v[48:63], v[112:115], v[144:147], v[48:63]
    buffer_load_dwordx4 v[184:187], v2, s[28:31], s57 offen offset:2048 sc1
    s_waitcnt vmcnt(9)
    s_waitcnt lgkmcnt(4)
    v_mfma_f32_32x32x16_bf16 v[64:79], v[124:127], v[148:151], v[64:79]
    ds_read_b64_tr_b16 v[84:85], v5 offset:27648
    ds_read_b64_tr_b16 v[86:87], v5 offset:28672
    ds_read_b64_tr_b16 v[80:81], v4 offset:27648
    ds_read_b64_tr_b16 v[82:83], v4 offset:28672
    v_mfma_f32_32x32x16_bf16 v[48:63], v[120:123], v[148:151], v[48:63]
    buffer_load_dwordx4 v[188:191], v2, s[28:31], s57 offen offset:3072 sc1
    s_waitcnt vmcnt(9)
    s_waitcnt lgkmcnt(4)
    v_mfma_f32_32x32x16_bf16 v[64:79], v[132:135], v[152:155], v[64:79]
    ds_read_b64_tr_b16 v[92:93], v5 offset:31744
    ds_read_b64_tr_b16 v[94:95], v5 offset:32768
    ds_read_b64_tr_b16 v[88:89], v4 offset:31744
    ds_read_b64_tr_b16 v[90:91], v4 offset:32768
    v_mfma_f32_32x32x16_bf16 v[48:63], v[128:131], v[152:155], v[48:63]
    s_add_u32 s57, s58, 6307840
    buffer_load_dwordx4 v[192:195], v2, s[28:31], s57 offen offset:0 sc1
    s_waitcnt vmcnt(9)
    s_waitcnt lgkmcnt(4)
    v_mfma_f32_32x32x16_bf16 v[64:79], v[84:87], v[156:159], v[64:79]
    ds_read_b64_tr_b16 v[100:101], v5 offset:35840
    ds_read_b64_tr_b16 v[102:103], v5 offset:36864
    ds_read_b64_tr_b16 v[96:97], v4 offset:35840
    ds_read_b64_tr_b16 v[98:99], v4 offset:36864
    v_mfma_f32_32x32x16_bf16 v[48:63], v[80:83], v[156:159], v[48:63]
    buffer_load_dwordx4 v[196:199], v2, s[28:31], s57 offen offset:1024 sc1
    s_barrier
    s_lshl_b32 s55, s50, 12
    s_add_u32 s55, s55, 118784
    v_add_u32 v10, s55, v2
    s_xor_b32 s55, s50, 2
    s_lshl_b32 s55, s55, 12
    s_add_u32 s55, s55, 118784
    v_add_u32 v11, s55, v2
    s_waitcnt vmcnt(9)
    s_waitcnt lgkmcnt(4)
    v_mfma_f32_32x32x16_bf16 v[64:79], v[92:95], v[160:163], v[64:79]
    ds_read_b64_tr_b16 v[108:109], v5 offset:39936
    ds_read_b64_tr_b16 v[110:111], v5 offset:40960
    ds_read_b64_tr_b16 v[104:105], v4 offset:39936
    ds_read_b64_tr_b16 v[106:107], v4 offset:40960
    v_mfma_f32_32x32x16_bf16 v[48:63], v[88:91], v[160:163], v[48:63]
    buffer_load_dwordx4 v[136:139], v2, s[28:31], s57 offen offset:2048 sc1
    s_waitcnt vmcnt(9)
    s_waitcnt lgkmcnt(4)
    v_mfma_f32_32x32x16_bf16 v[64:79], v[100:103], v[164:167], v[64:79]
    ds_read_b64_tr_b16 v[116:117], v5 offset:44032
    ds_read_b64_tr_b16 v[118:119], v5 offset:45056
    ds_read_b64_tr_b16 v[112:113], v4 offset:44032
    ds_read_b64_tr_b16 v[114:115], v4 offset:45056
    v_mfma_f32_32x32x16_bf16 v[48:63], v[96:99], v[164:167], v[48:63]
    buffer_load_dwordx4 v[140:143], v2, s[28:31], s57 offen offset:3072 sc1
    s_waitcnt vmcnt(9)
    s_waitcnt lgkmcnt(4)
    v_mfma_f32_32x32x16_bf16 v[64:79], v[108:111], v[168:171], v[64:79]
    ds_read_b64_tr_b16 v[124:125], v5 offset:48128
    ds_read_b64_tr_b16 v[126:127], v5 offset:49152
    ds_read_b64_tr_b16 v[120:121], v4 offset:48128
    ds_read_b64_tr_b16 v[122:123], v4 offset:49152
    v_mfma_f32_32x32x16_bf16 v[48:63], v[104:107], v[168:171], v[48:63]
    s_add_u32 s57, s58, 6311936
    buffer_load_dwordx4 v[144:147], v2, s[28:31], s57 offen offset:0 sc1
    s_waitcnt vmcnt(9)
    s_waitcnt lgkmcnt(4)
    v_mfma_f32_32x32x16_bf16 v[64:79], v[116:119], v[172:175], v[64:79]
    ds_read_b64_tr_b16 v[132:133], v5 offset:52224
    ds_read_b64_tr_b16 v[134:135], v5 offset:53248
    ds_read_b64_tr_b16 v[128:129], v4 offset:52224
    ds_read_b64_tr_b16 v[130:131], v4 offset:53248
    v_mfma_f32_32x32x16_bf16 v[48:63], v[112:115], v[172:175], v[48:63]
    buffer_load_dwordx4 v[148:151], v2, s[28:31], s57 offen offset:1024 sc1
    s_waitcnt vmcnt(9)
    s_waitcnt lgkmcnt(4)
    v_mfma_f32_32x32x16_bf16 v[64:79], v[124:127], v[176:179], v[64:79]
    ds_read_b64_tr_b16 v[84:85], v5 offset:56320
    ds_read_b64_tr_b16 v[86:87], v5 offset:57344
    ds_read_b64_tr_b16 v[80:81], v4 offset:56320
    ds_read_b64_tr_b16 v[82:83], v4 offset:57344
    v_mfma_f32_32x32x16_bf16 v[48:63], v[120:123], v[176:179], v[48:63]
    buffer_load_dwordx4 v[152:155], v2, s[28:31], s57 offen offset:2048 sc1
    s_waitcnt vmcnt(9)
    s_waitcnt lgkmcnt(4)
    v_mfma_f32_32x32x16_bf16 v[64:79], v[132:135], v[180:183], v[64:79]
    ds_read_b64_tr_b16 v[92:93], v5 offset:60416
    ds_read_b64_tr_b16 v[94:95], v5 offset:61440
    ds_read_b64_tr_b16 v[88:89], v4 offset:60416
    ds_read_b64_tr_b16 v[90:91], v4 offset:61440
    v_mfma_f32_32x32x16_bf16 v[48:63], v[128:131], v[180:183], v[48:63]
    buffer_load_dwordx4 v[156:159], v2, s[28:31], s57 offen offset:3072 sc1
    s_waitcnt vmcnt(9)
    s_waitcnt lgkmcnt(4)
    v_mfma_f32_32x32x16_bf16 v[64:79], v[84:87], v[184:187], v[64:79]
    ds_read_b64_tr_b16 v[100:101], v5 offset:64512
    ds_read_b64_tr_b16 v[102:103], v15 offset:0
    ds_read_b64_tr_b16 v[96:97], v4 offset:64512
    ds_read_b64_tr_b16 v[98:99], v14 offset:0
    v_mfma_f32_32x32x16_bf16 v[48:63], v[80:83], v[184:187], v[48:63]
    s_add_u32 s57, s58, 6316032
    buffer_load_dwordx4 v[160:163], v2, s[28:31], s57 offen offset:0 sc1
    s_waitcnt vmcnt(9)
    s_waitcnt lgkmcnt(4)
    v_mfma_f32_32x32x16_bf16 v[64:79], v[92:95], v[188:191], v[64:79]
    ds_read_b64_tr_b16 v[108:109], v15 offset:3072
    ds_read_b64_tr_b16 v[110:111], v15 offset:4096
    ds_read_b64_tr_b16 v[104:105], v14 offset:3072
    ds_read_b64_tr_b16 v[106:107], v14 offset:4096
    v_mfma_f32_32x32x16_bf16 v[48:63], v[88:91], v[188:191], v[48:63]
    buffer_load_dwordx4 v[164:167], v2, s[28:31], s57 offen offset:1024 sc1
    s_waitcnt vmcnt(9)
    s_waitcnt lgkmcnt(4)
    v_mfma_f32_32x32x16_bf16 v[64:79], v[100:103], v[192:195], v[64:79]
    ds_read_b64_tr_b16 v[116:117], v15 offset:7168
    ds_read_b64_tr_b16 v[118:119], v15 offset:8192
    ds_read_b64_tr_b16 v[112:113], v14 offset:7168
    ds_read_b64_tr_b16 v[114:115], v14 offset:8192
    v_mfma_f32_32x32x16_bf16 v[48:63], v[96:99], v[192:195], v[48:63]
    buffer_load_dwordx4 v[168:171], v2, s[28:31], s57 offen offset:2048 sc1
    s_waitcnt vmcnt(9)
    s_waitcnt lgkmcnt(4)
    v_mfma_f32_32x32x16_bf16 v[64:79], v[108:111], v[196:199], v[64:79]
    ds_read_b64_tr_b16 v[124:125], v15 offset:11264
    ds_read_b64_tr_b16 v[126:127], v15 offset:12288
    ds_read_b64_tr_b16 v[120:121], v14 offset:11264
    ds_read_b64_tr_b16 v[122:123], v14 offset:12288
    v_mfma_f32_32x32x16_bf16 v[48:63], v[104:107], v[196:199], v[48:63]
    buffer_load_dwordx4 v[172:175], v2, s[28:31], s57 offen offset:3072 sc1
    s_waitcnt vmcnt(9)
    s_waitcnt lgkmcnt(4)
    v_mfma_f32_32x32x16_bf16 v[64:79], v[116:119], v[136:139], v[64:79]
    ds_read_b64_tr_b16 v[132:133], v15 offset:15360
    ds_read_b64_tr_b16 v[134:135], v15 offset:16384
    ds_read_b64_tr_b16 v[128:129], v14 offset:15360
    ds_read_b64_tr_b16 v[130:131], v14 offset:16384
    v_mfma_f32_32x32x16_bf16 v[48:63], v[112:115], v[136:139], v[48:63]
    s_add_u32 s57, s58, 6320128
    s_cmp_eq_u32 s95, 0
    s_cselect_b32 s57, 2146435072, s57
    buffer_load_dwordx4 v[176:179], v2, s[28:31], s57 offen offset:0 sc1
    s_waitcnt vmcnt(9)
    s_waitcnt lgkmcnt(4)
    v_mfma_f32_32x32x16_bf16 v[64:79], v[124:127], v[140:143], v[64:79]
    ds_read_b64_tr_b16 v[84:85], v15 offset:19456
    ds_read_b64_tr_b16 v[86:87], v15 offset:20480
    ds_read_b64_tr_b16 v[80:81], v14 offset:19456
    ds_read_b64_tr_b16 v[82:83], v14 offset:20480
    v_mfma_f32_32x32x16_bf16 v[48:63], v[120:123], v[140:143], v[48:63]
    buffer_load_dwordx4 v[180:183], v2, s[28:31], s57 offen offset:1024 sc1
    s_waitcnt vmcnt(9)
    s_waitcnt lgkmcnt(4)
    v_mfma_f32_32x32x16_bf16 v[64:79], v[132:135], v[144:147], v[64:79]
    ds_read_b64_tr_b16 v[92:93], v15 offset:23552
    ds_read_b64_tr_b16 v[94:95], v15 offset:24576
    ds_read_b64_tr_b16 v[88:89], v14 offset:23552
    ds_read_b64_tr_b16 v[90:91], v14 offset:24576
    v_mfma_f32_32x32x16_bf16 v[48:63], v[128:131], v[144:147], v[48:63]
    s_waitcnt vmcnt(8)
    s_waitcnt lgkmcnt(4)
    v_mfma_f32_32x32x16_bf16 v[64:79], v[84:87], v[148:151], v[64:79]
    ds_read_b64_tr_b16 v[100:101], v15 offset:27648
    ds_read_b64_tr_b16 v[102:103], v15 offset:28672
    ds_read_b64_tr_b16 v[96:97], v14 offset:27648
    ds_read_b64_tr_b16 v[98:99], v14 offset:28672
    v_mfma_f32_32x32x16_bf16 v[48:63], v[80:83], v[148:151], v[48:63]
    s_waitcnt vmcnt(7)
    s_waitcnt lgkmcnt(4)
    v_mfma_f32_32x32x16_bf16 v[64:79], v[92:95], v[152:155], v[64:79]
    ds_read_b64_tr_b16 v[108:109], v15 offset:31744
    ds_read_b64_tr_b16 v[110:111], v15 offset:32768
    ds_read_b64_tr_b16 v[104:105], v14 offset:31744
    ds_read_b64_tr_b16 v[106:107], v14 offset:32768
    v_mfma_f32_32x32x16_bf16 v[48:63], v[88:91], v[152:155], v[48:63]
    ds_read_b64_tr_b16 v[116:117], v15 offset:35840
    ds_read_b64_tr_b16 v[118:119], v15 offset:36864
    ds_read_b64_tr_b16 v[112:113], v14 offset:35840
    ds_read_b64_tr_b16 v[114:115], v14 offset:36864
    s_waitcnt vmcnt(6)
    s_waitcnt lgkmcnt(8)
    v_mfma_f32_32x32x16_bf16 v[64:79], v[100:103], v[156:159], v[64:79]
    ds_read_b64_tr_b16 v[124:125], v15 offset:39936
    ds_read_b64_tr_b16 v[126:127], v15 offset:40960
    ds_read_b64_tr_b16 v[120:121], v14 offset:39936
    ds_read_b64_tr_b16 v[122:123], v14 offset:40960
    v_mfma_f32_32x32x16_bf16 v[48:63], v[96:99], v[156:159], v[48:63]
    ds_read_b64_tr_b16 v[132:133], v15 offset:44032
    ds_read_b64_tr_b16 v[134:135], v15 offset:45056
    ds_read_b64_tr_b16 v[128:129], v14 offset:44032
    s_waitcnt lgkmcnt(14)
    ds_read_b64_tr_b16 v[130:131], v14 offset:45056
    s_waitcnt vmcnt(5)
    s_waitcnt lgkmcnt(12)
    v_mfma_f32_32x32x16_bf16 v[64:79], v[108:111], v[160:163], v[64:79]
    ds_read_b64_tr_b16 v[84:85], v15 offset:46080
    ds_read_b64_tr_b16 v[86:87], v15 offset:47104
    ds_read_b64_tr_b16 v[80:81], v14 offset:46080
    s_waitcnt lgkmcnt(14)
    ds_read_b64_tr_b16 v[82:83], v14 offset:47104
    v_mfma_f32_32x32x16_bf16 v[48:63], v[104:107], v[160:163], v[48:63]
    s_waitcnt lgkmcnt(14)
    ds_read_b64_tr_b16 v[92:93], v15 offset:48128
    s_waitcnt lgkmcnt(14)
    ds_read_b64_tr_b16 v[94:95], v15 offset:49152
    s_waitcnt lgkmcnt(14)
    ds_read_b64_tr_b16 v[88:89], v14 offset:48128
    s_waitcnt lgkmcnt(14)
    ds_read_b64_tr_b16 v[90:91], v14 offset:49152
    s_waitcnt vmcnt(4)
    v_mfma_f32_32x32x16_bf16 v[64:79], v[116:119], v[164:167], v[64:79]
    s_waitcnt vmcnt(3)
    s_waitcnt lgkmcnt(12)
    v_mfma_f32_32x32x16_bf16 v[64:79], v[124:127], v[168:171], v[64:79]
    s_waitcnt vmcnt(2)
    s_waitcnt lgkmcnt(8)
    v_mfma_f32_32x32x16_bf16 v[64:79], v[132:135], v[172:175], v[64:79]
    s_waitcnt vmcnt(1)
    s_waitcnt lgkmcnt(4)
    v_mfma_f32_32x32x16_bf16 v[64:79], v[84:87], v[176:179], v[64:79]
    s_waitcnt vmcnt(0)
    s_waitcnt lgkmcnt(0)
    v_mfma_f32_32x32x16_bf16 v[64:79], v[92:95], v[180:183], v[64:79]
    v_mfma_f32_32x32x16_bf16 v[48:63], v[112:115], v[164:167], v[48:63]
    v_mfma_f32_32x32x16_bf16 v[48:63], v[120:123], v[168:171], v[48:63]
    s_nop 9
    ds_write_b128 v10, v[64:67] offset:0
    v_mfma_f32_32x32x16_bf16 v[48:63], v[128:131], v[172:175], v[48:63]
    ds_write_b128 v10, v[68:71] offset:1024
    v_mfma_f32_32x32x16_bf16 v[48:63], v[80:83], v[176:179], v[48:63]
    ds_write_b128 v10, v[72:75] offset:2048
    v_mfma_f32_32x32x16_bf16 v[48:63], v[88:91], v[180:183], v[48:63]
    ds_write_b128 v10, v[76:79] offset:3072
    s_waitcnt lgkmcnt(0)
    s_barrier
    ds_read_b128 v[16:19], v11 offset:0
    ds_read_b128 v[20:23], v11 offset:1024
    ds_read_b128 v[24:27], v11 offset:2048
    ds_read_b128 v[28:31], v11 offset:3072
    s_waitcnt lgkmcnt(3)
    s_nop 3
    v_add_f32 v16, v16, v48
    v_add_f32 v17, v17, v49
    v_add_f32 v18, v18, v50
    v_add_f32 v19, v19, v51
    s_waitcnt lgkmcnt(2)
    v_add_f32 v20, v20, v52
    v_add_f32 v21, v21, v53
    v_add_f32 v22, v22, v54
    v_add_f32 v23, v23, v55
    s_waitcnt lgkmcnt(1)
    v_add_f32 v24, v24, v56
    v_add_f32 v25, v25, v57
    v_add_f32 v26, v26, v58
    v_add_f32 v27, v27, v59
    s_waitcnt lgkmcnt(0)
    v_add_f32 v28, v28, v60
    v_add_f32 v29, v29, v61
    v_add_f32 v30, v30, v62
    v_add_f32 v31, v31, v63
    v_cvt_pk_bf16_f32 v32, v16, v17
    v_cvt_pk_bf16_f32 v33, v18, v19
    v_cvt_pk_bf16_f32 v34, v20, v21
    v_cvt_pk_bf16_f32 v35, v22, v23
    v_cvt_pk_bf16_f32 v36, v24, v25
    v_cvt_pk_bf16_f32 v37, v26, v27
    v_cvt_pk_bf16_f32 v38, v28, v29
    v_cvt_pk_bf16_f32 v39, v30, v31
    v_lshrrev_b32 v10, 5, v1
    v_lshl_add_u32 v9, v10, 3, v9
    v_permlane32_swap_b32 v32, v34
    v_permlane32_swap_b32 v33, v35
    buffer_store_dwordx4 v[32:35], v9, s[24:27], 0 offen offset:0
    v_permlane32_swap_b32 v36, v38
    v_permlane32_swap_b32 v37, v39
    buffer_store_dwordx4 v[36:39], v9, s[24:27], 0 offen offset:32
    s_endpgm
L_grx_50:
    buffer_load_dwordx4 v[148:151], v8, s[28:31], 0 offen sc1
    buffer_load_dwordx2 v[156:157], v7, s[28:31], 0 offen sc1
    s_waitcnt vmcnt(0)
    s_add_u32 s55, s55, 1
    s_cmp_lt_u32 s55, 200000
    s_cbranch_scc1 L_gr_49
    s_branch L_grd_51
L_lwx_53:
    s_mov_b32 s55, 0
L_lwy_103:
    ds_read_b32 v10, v102 offset:2852
    s_waitcnt lgkmcnt(0)
    v_cmp_gt_u32 vcc, 4, v10
    s_cbranch_vccz L_lw_52
    s_add_u32 s55, s55, 1
    s_cmp_lt_u32 s55, 1600000
    s_cbranch_scc1 L_lwy_103
    s_branch L_lw_52
L_lwx_55:
    s_mov_b32 s55, 0
L_lwy_104:
    ds_read_b32 v10, v102 offset:2856
    s_waitcnt lgkmcnt(0)
    v_cmp_gt_u32 vcc, 4, v10
    s_cbranch_vccz L_lw_54
    s_add_u32 s55, s55, 1
    s_cmp_lt_u32 s55, 1600000
    s_cbranch_scc1 L_lwy_104
    s_branch L_lw_54
L_pollx_59:
    s_add_u32 s55, s55, 1
    s_cmp_lt_u32 s55, 200000
    s_cbranch_scc1 L_poll_57
    s_branch L_polld_58
L_nohalo_60:
    s_waitcnt vmcnt(0)
    v_mov_b32 v120, 0
    v_mov_b32 v121, 0
    v_mov_b32 v122, 0
    v_mov_b32 v123, 0
    v_mov_b32 v124, 0
    v_mov_b32 v125, 0
    v_mov_b32 v126, 0
    v_mov_b32 v127, 0
    v_mov_b32 v128, 0
    v_mov_b32 v129, 0
    v_mov_b32 v130, 0
    v_mov_b32 v131, 0
    v_mov_b32 v132, 0
    v_mov_b32 v133, 0
    v_mov_b32 v134, 0
    v_mov_b32 v135, 0
    s_cmp_eq_u32 s46, 1
    s_cbranch_scc1 L_halow_61
    v_mov_b32 v136, 0
    v_mov_b32 v137, 0
    v_mov_b32 v138, 0
    v_mov_b32 v139, 0
    v_mov_b32 v140, 0
    v_mov_b32 v141, 0
    v_mov_b32 v142, 0
    v_mov_b32 v143, 0
    v_mov_b32 v144, 0
    v_mov_b32 v145, 0
    v_mov_b32 v146, 0
    v_mov_b32 v147, 0
    v_mov_b32 v148, 0
    v_mov_b32 v149, 0
    v_mov_b32 v150, 0
    v_mov_b32 v151, 0
    s_branch L_halow_61
L_fb_64:
    s_lshl_b32 s55, s46, 2
    s_add_u32 s55, s55, s51
    s_sub_i32 s55, 8, s55
    s_max_i32 s89, s55, 0
    v_mov_b32 v14, 0xf149f2ca
    s_mov_b32 s90, s89
L_fbl_106:
    s_lshl_b32 s55, s90, 11
    v_add_u32 v10, s55, v100
    s_mul_i32 s55, s90, 2080
    v_add_u32 v11, s55, v101
    ds_read_b128 v[60:63], v10
    ds_read_b128 v[68:71], v11
    ds_read_b128 v[72:75], v11 offset:1040
    s_waitcnt lgkmcnt(0)
    s_cmp_eq_u32 s90, 8
    s_cbranch_scc1 L_fbm_107
    s_cmp_eq_u32 s90, 0
    s_cbranch_scc1 L_fbn_108
    v_mfma_f32_32x32x16_bf16 v[20:35], v[60:63], v[160:163], 0
    s_branch L_fbc_109
L_fbm_107:
    v_mfma_f32_32x32x16_bf16 v[20:35], v[60:63], v[160:163], v[164:179]
    s_branch L_fbc_109
L_fbn_108:
    v_mfma_f32_32x32x16_bf16 v[20:35], v[60:63], v[160:163], v[180:195]
L_fbc_109:
    s_nop 11
    v_max_f32 v14, v14, v20
    v_max_f32 v14, v14, v21
    v_max_f32 v14, v14, v22
    v_max_f32 v14, v14, v23
    v_max_f32 v14, v14, v24
    v_max_f32 v14, v14, v25
    v_max_f32 v14, v14, v26
    v_max_f32 v14, v14, v27
    v_max_f32 v14, v14, v28
    v_max_f32 v14, v14, v29
    v_max_f32 v14, v14, v30
    v_max_f32 v14, v14, v31
    v_max_f32 v14, v14, v32
    v_max_f32 v14, v14, v33
    v_max_f32 v14, v14, v34
    v_max_f32 v14, v14, v35
    s_add_u32 s90, s90, 1
    s_cmp_le_u32 s90, 8
    s_cbranch_scc1 L_fbl_106
    v_mov_b32 v15, v14
    s_nop 1
    v_permlane32_swap_b32 v14, v15
    v_max_f32 v14, v14, v15
    s_mov_b32 s90, s89
    v_mov_b32 v84, 0
    v_mov_b32 v85, 0
    v_mov_b32 v86, 0
    v_mov_b32 v87, 0
    v_mov_b32 v88, 0
    v_mov_b32 v89, 0
    v_mov_b32 v90, 0
    v_mov_b32 v91, 0
    v_mov_b32 v92, 0
    v_mov_b32 v93, 0
    v_mov_b32 v94, 0
    v_mov_b32 v95, 0
    v_mov_b32 v96, 0
    v_mov_b32 v97, 0
    v_mov_b32 v98, 0
    v_mov_b32 v99, 0
L_fbl_110:
    s_lshl_b32 s55, s90, 11
    v_add_u32 v10, s55, v100
    s_mul_i32 s55, s90, 2080
    v_add_u32 v11, s55, v101
    ds_read_b128 v[60:63], v10
    ds_read_b128 v[68:71], v11
    ds_read_b128 v[72:75], v11 offset:1040
    s_waitcnt lgkmcnt(0)
    s_cmp_eq_u32 s90, 8
    s_cbranch_scc1 L_fbm_111
    s_cmp_eq_u32 s90, 0
    s_cbranch_scc1 L_fbn_112
    v_mfma_f32_32x32x16_bf16 v[20:35], v[60:63], v[160:163], 0
    s_branch L_fbc_113
L_fbm_111:
    v_mfma_f32_32x32x16_bf16 v[20:35], v[60:63], v[160:163], v[164:179]
    s_branch L_fbc_113
L_fbn_112:
    v_mfma_f32_32x32x16_bf16 v[20:35], v[60:63], v[160:163], v[180:195]
L_fbc_113:
    s_nop 11
    v_sub_f32 v20, v20, v14
    v_exp_f32 v20, v20
    v_sub_f32 v21, v21, v14
    v_exp_f32 v21, v21
    v_sub_f32 v22, v22, v14
    v_exp_f32 v22, v22
    v_sub_f32 v23, v23, v14
    v_exp_f32 v23, v23
    v_sub_f32 v24, v24, v14
    v_exp_f32 v24, v24
    v_sub_f32 v25, v25, v14
    v_exp_f32 v25, v25
    v_sub_f32 v26, v26, v14
    v_exp_f32 v26, v26
    v_sub_f32 v27, v27, v14
    v_exp_f32 v27, v27
    v_sub_f32 v28, v28, v14
    v_exp_f32 v28, v28
    v_sub_f32 v29, v29, v14
    v_exp_f32 v29, v29
    v_sub_f32 v30, v30, v14
    v_exp_f32 v30, v30
    v_sub_f32 v31, v31, v14
    v_exp_f32 v31, v31
    v_sub_f32 v32, v32, v14
    v_exp_f32 v32, v32
    v_sub_f32 v33, v33, v14
    v_exp_f32 v33, v33
    v_sub_f32 v34, v34, v14
    v_exp_f32 v34, v34
    v_sub_f32 v35, v35, v14
    v_exp_f32 v35, v35
    v_cvt_pk_bf16_f32 v52, v20, v21
    v_cvt_pk_bf16_f32 v53, v22, v23
    v_cvt_pk_bf16_f32 v54, v24, v25
    v_cvt_pk_bf16_f32 v55, v26, v27
    v_cvt_pk_bf16_f32 v56, v28, v29
    v_cvt_pk_bf16_f32 v57, v30, v31
    v_cvt_pk_bf16_f32 v58, v32, v33
    v_cvt_pk_bf16_f32 v59, v34, v35
    v_mfma_f32_32x32x16_bf16 v[84:99], v[68:71], v[52:55], v[84:99]
    s_nop 0
    v_mfma_f32_32x32x16_bf16 v[84:99], v[72:75], v[56:59], v[84:99]
    s_add_u32 s90, s90, 1
    s_cmp_le_u32 s90, 8
    s_cbranch_scc1 L_fbl_110
    s_branch L_fbret_65
L_rdx_67:
    s_mov_b32 s55, 0
L_poll_114:
    buffer_load_dword v103, v102, s[28:31], 0 offen sc1
    s_waitcnt vmcnt(0)
    v_cmp_ne_u32 vcc, s52, v103
    s_cbranch_vccnz L_pollx_116
L_polld_115:
    s_branch L_rdc_66
L_safe_68:
    buffer_store_dwordx4 v[12:15], v2, s[28:31], s61 offen sc1
    s_branch L_back_69
L_lwx_71:
    s_mov_b32 s55, 0
L_lwy_117:
    ds_read_b32 v10, v102 offset:2836
    s_waitcnt lgkmcnt(0)
    v_cmp_gt_u32 vcc, 4, v10
    s_cbranch_vccz L_lw_70
    s_add_u32 s55, s55, 1
    s_cmp_lt_u32 s55, 1600000
    s_cbranch_scc1 L_lwy_117
    s_branch L_lw_70
L_safe_72:
    buffer_store_dword v11, v10, s[28:31], 0 offen sc1
    s_branch L_back_73
L_pollx_76:
    s_add_u32 s55, s55, 1
    s_cmp_lt_u32 s55, 200000
    s_cbranch_scc1 L_poll_74
    s_branch L_polld_75
L_lwx_78:
    s_mov_b32 s55, 0
L_lwy_118:
    ds_read_b32 v15, v14 offset:2872
    s_waitcnt lgkmcnt(0)
    v_cmp_gt_u32 vcc, 2, v15
    s_cbranch_vccz L_lw_77
    s_add_u32 s55, s55, 1
    s_cmp_lt_u32 s55, 1600000
    s_cbranch_scc1 L_lwy_118
    s_branch L_lw_77
L_safe_79:
    buffer_store_dwordx4 v[248:251], v2, s[28:31], s56 offen sc1
    buffer_store_dwordx4 v[252:255], v2, s[28:31], s56 offen offset:1024 sc1
    s_branch L_back_80
L_safe_81:
    buffer_store_dwordx2 v[12:13], v14, s[28:31], s57 offen sc1
    s_branch L_back_82
L_lwx_84:
    s_mov_b32 s55, 0
L_lwy_119:
    ds_read_b32 v10, v246 offset:2868
    s_waitcnt lgkmcnt(0)
    v_cmp_gt_u32 vcc, 4, v10
    s_cbranch_vccz L_lw_83
    s_add_u32 s55, s55, 1
    s_cmp_lt_u32 s55, 1600000
    s_cbranch_scc1 L_lwy_119
    s_branch L_lw_83
L_safe_85:
    buffer_store_dword v11, v10, s[28:31], 0 offen sc1
    s_branch L_back_86
L_pollx_89:
    s_add_u32 s55, s55, 1
    s_cmp_lt_u32 s55, 200000
    s_cbranch_scc1 L_poll_87
    s_branch L_polld_88
L_lwx_91:
    s_mov_b32 s55, 0
L_lwy_120:
    ds_read_b32 v10, v246 offset:2824
    s_waitcnt lgkmcnt(0)
    v_cmp_gt_u32 vcc, 4, v10
    s_cbranch_vccz L_lw_90
    s_add_u32 s55, s55, 1
    s_cmp_lt_u32 s55, 1600000
    s_cbranch_scc1 L_lwy_120
    s_branch L_lw_90
L_safe_92:
    buffer_store_dwordx4 v[228:231], v2, s[28:31], s60 offen offset:0 sc1
    buffer_store_dwordx4 v[232:235], v2, s[28:31], s60 offen offset:1024 sc1
    s_branch L_back_93
L_safe_94:
    buffer_store_dword v11, v10, s[28:31], 0 offen sc1
    s_branch L_back_95
L_pollx_98:
    s_add_u32 s55, s55, 1
    s_cmp_lt_u32 s55, 200000
    s_cbranch_scc1 L_poll_96
    s_branch L_polld_97
L_lwx_100:
    s_mov_b32 s55, 0
L_lwy_121:
    ds_read_b32 v10, v246 offset:2828
    s_waitcnt lgkmcnt(0)
    v_cmp_gt_u32 vcc, 4, v10
    s_cbranch_vccz L_lw_99
    s_add_u32 s55, s55, 1
    s_cmp_lt_u32 s55, 1600000
    s_cbranch_scc1 L_lwy_121
    s_branch L_lw_99
L_lwx_102:
    s_mov_b32 s55, 0
L_lwy_122:
    ds_read_b32 v10, v246 offset:2832
    s_waitcnt lgkmcnt(0)
    v_cmp_gt_u32 vcc, 4, v10
    s_cbranch_vccz L_lw_101
    s_add_u32 s55, s55, 1
    s_cmp_lt_u32 s55, 1600000
    s_cbranch_scc1 L_lwy_122
    s_branch L_lw_101
L_pollx_116:
    s_add_u32 s55, s55, 1
    s_cmp_lt_u32 s55, 200000
    s_cbranch_scc1 L_poll_114
    s_branch L_polld_115
L_codeend:
.section .rodata,"a"
.p2align 6
.amdhsa_kernel sequential_preLN__sliding_block__dense_activation_squared_relu__prompt_kernel
  .amdhsa_next_free_vgpr 256
  .amdhsa_next_free_sgpr 102
  .amdhsa_accum_offset 256
  .amdhsa_group_segment_fixed_size 0
  .amdhsa_kernarg_size 88
  .amdhsa_user_sgpr_count 2
  .amdhsa_user_sgpr_kernarg_segment_ptr 1
  .amdhsa_system_sgpr_workgroup_id_x 1
.end_amdhsa_kernel
```
